```python
import torch

def _softmax(x, axis=-1):
    return torch.softmax(x, dim=axis)

def _gelu(x):
    return torch.nn.functional.gelu(x, approximate='tanh')

def _silu(x):
    return torch.nn.functional.silu(x)

def _sigmoid(x):
    return torch.sigmoid(x)

def _layernorm(x, axis=-1, eps=1e-05):
    m = x.mean(dim=axis, keepdim=True)
    v = x.var(dim=axis, keepdim=True, unbiased=False)
    return (x - m) / torch.sqrt(v + eps)

def _scatter_add(tgt, idx, src, axis=0):
    return tgt.clone().index_add_(axis, idx, src)

def _segment_sum(src, seg, n):
    out = torch.zeros((n,) + src.shape[1:], dtype=src.dtype)
    return out.index_add_(0, seg, src)

def _pad(x, pw):
    flat = tuple((v for pair in reversed(pw) for v in pair))
    return torch.nn.functional.pad(x, flat)
kernel_name = 'adaLN_cond__ssm_conv_h3__mixer_s_mlp__prompt'

def setup_inputs():

    _w = lambda a: (lambda t: t.to(torch.bfloat16) if t.is_floating_point() else t)(torch.as_tensor(a))

    def _A_setup():
        B, S, D = (1, 2048, 512)
        ks = 4
        return {'q': _w((lambda *s: torch.randn(*s, dtype=torch.bfloat16) * 0.05)(B, S, D)), 'k': _w((lambda *s: torch.randn(*s, dtype=torch.bfloat16) * 0.8)(B, S, D)), 'v': _w((lambda *s: torch.randn(*s, dtype=torch.bfloat16) * 0.8)(B, S, D)), 'shift_k': _w((lambda *s: torch.randn(*s, dtype=torch.bfloat16) * 0.8)(D, ks) * 0.5), 'ssm_k': _w((lambda *s: torch.randn(*s, dtype=torch.bfloat16) * 0.8)(D, S) * (1.0 / S ** 0.5)), 'ssm_D': _w((lambda *s: torch.randn(*s, dtype=torch.bfloat16) * 0.8)(D))}
    _A_in = _A_setup()

    def _B_setup():
        B, S, D, F = (1, 2048, 512, 1792)
        return {'x': _w((lambda *s: torch.randn(*s, dtype=torch.bfloat16) * 0.05)(B, S, D)), 'w1': _w((lambda *s: torch.randn(*s, dtype=torch.bfloat16) * 3.2)(D, D) * D ** (-0.5)), 'w2': _w((lambda *s: torch.randn(*s, dtype=torch.bfloat16) * 3.2)(D, D) * D ** (-0.5)), 'w3': _w((lambda *s: torch.randn(*s, dtype=torch.bfloat16) * 3.2)(D, F) * D ** (-0.5)), 'w4': _w((lambda *s: torch.randn(*s, dtype=torch.bfloat16) * 3.2)(F, D) * F ** (-0.5))}
    _B_in = _B_setup()
    return {'A_q': _A_in['q'], 'A_k': _A_in['k'], 'A_v': _A_in['v'], 'A_shift_k': _A_in['shift_k'], 'A_ssm_k': _A_in['ssm_k'], 'A_ssm_D': _A_in['ssm_D'], 'B_x': _B_in['x'], 'B_w1': _B_in['w1'], 'B_w2': _B_in['w2'], 'B_w3': _B_in['w3'], 'B_w4': _B_in['w4'], 'c': _w((lambda *s: torch.randn(*s, dtype=torch.bfloat16) * 0.1)(1, 512) * 8.0), 'w_mod': _w((lambda *s: torch.randn(*s, dtype=torch.bfloat16) * 0.1)(512, 6 * 512) * 512 ** (-0.5) * 8.0)}

def reference(A_q, A_k, A_v, A_shift_k, A_ssm_k, A_ssm_D, B_x, B_w1, B_w2, B_w3, B_w4, c, w_mod):

    def _A_ref(q, k, v, shift_k, ssm_k, ssm_D):
        B, S, D = q.shape
        ks = shift_k.shape[-1]
        k_pad = _pad(k, ((0, 0), (ks - 1, 0), (0, 0)))
        k_shift = torch.zeros_like(k)
        for t in range(ks):
            k_shift = k_shift + k_pad[:, t:t + S, :] * shift_k[:, ks - 1 - t][None, None, :]
        kv = k_shift * v
        L = 2 * S
        kv_pad = _pad(kv, ((0, 0), (0, S), (0, 0)))
        kf_pad = _pad(ssm_k, ((0, 0), (0, S)))
        kv_f = (lambda x, axes=(-2, -1): torch.fft.rfft2(x.float(), dim=axes))(kv_pad[:, None, :, :], axes=(1, 2))
        kf_f = (lambda x, axes=(-2, -1): torch.fft.rfft2(x.float(), dim=axes))(kf_pad[:, None, :], axes=(1, 2))
        kf_f = (lambda x, *d: x.permute(*d))(kf_f, 1, 2, 0)
        y_f = kv_f * kf_f[None, :, :, :]
        y = (lambda x, s, axes=(-2, -1): torch.fft.irfft2(x, s=s, dim=axes).to(torch.bfloat16))(y_f, (1, L), axes=(1, 2))[:, 0, :S, :]
        y = y + kv * ssm_D[None, None, :]
        return q * y

    def _B_ref(x, w1, w2, w3, w4):
        B, S, D = x.shape
        h = _gelu(_layernorm(x, axis=-1) @ w1)
        c = D // 4
        g0 = _pad(h[:, :, 0 * c:1 * c], ((0, 0), (1, 0), (0, 0)))[:, :S, :]
        g1 = _pad(h[:, :, 1 * c:2 * c], ((0, 0), (0, 1), (0, 0)))[:, 1:, :]
        g2 = _pad(h[:, :, 2 * c:3 * c], ((0, 0), (2, 0), (0, 0)))[:, :S, :]
        g3 = _pad(h[:, :, 3 * c:], ((0, 0), (0, 2), (0, 0)))[:, 2:, :]
        hs = torch.concatenate([g0, g1, g2, g3], axis=-1) @ w2
        x1 = x + hs
        h2 = _gelu(_layernorm(x1, axis=-1) @ w3) @ w4
        return x1 + h2
    x = A_q
    mod = (_silu(c) @ w_mod).reshape(c.shape[0], 6, 1, -1)
    sa, ca, ga, sb, cb, gb = (mod[:, 0].clone(), mod[:, 1].clone(), mod[:, 2].clone(), mod[:, 3].clone(), mod[:, 4].clone(), mod[:, 5].clone())
    h = _layernorm(x, axis=-1) * (1 + ca) + sa
    x = x + ga * _A_ref(h, A_k, A_v, A_shift_k, A_ssm_k, A_ssm_D)
    h = _layernorm(x, axis=-1) * (1 + cb) + sb
    x = x + gb * _B_ref(h, B_w1, B_w2, B_w3, B_w4)
    return x
```

```asm
; @launch grid=(256,1,1) block=(512,1,1) lds=163840
.amdgcn_target "amdgcn-amd-amdhsa--gfx950"
.text
.globl adaLN_cond__ssm_conv_h3__mixer_s_mlp__prompt_kernel
.p2align 8
.type adaLN_cond__ssm_conv_h3__mixer_s_mlp__prompt_kernel,@function
adaLN_cond__ssm_conv_h3__mixer_s_mlp__prompt_kernel:
    s_cmp_ge_u32 s2, 256
    s_cbranch_scc1 adaLN_cond__ssm_conv_h3__mixer_s_mlp__prompt_kernel_end
    s_load_dwordx16 s[64:79], s[0:1], 0
    s_load_dwordx16 s[80:95], s[0:1], 64
    v_lshrrev_b32 v1, 6, v0
    s_and_b32 s4, s2, 7
    s_lshr_b32 s5, s2, 3
    v_readfirstlane_b32 s6, v1
    v_and_b32 v1, 63, v0
    v_lshrrev_b32 v2, 3, v1
    v_lshlrev_b32 v2, 10, v2
    v_and_b32 v3, 7, v1
    v_lshl_add_u32 v2, v3, 4, v2
    s_lshl_b32 s3, s5, 16
    s_lshl_b32 s7, s4, 7
    s_add_u32 s20, s3, s7
    v_add_u32 v8, s20, v2
    v_add_u32 v8, 0xffffe000, v8
    v_cmp_gt_u32 vcc, 40, v1
    v_mov_b32 v3, 2147483648
    s_nop 0
    v_cndmask_b32 v8, v8, v3, vcc
    s_mov_b32 s50, s20
    s_lshl_b32 s3, s6, 13
    s_add_u32 s20, s20, s3
    s_lshl_b32 s23, s6, 10
    v_and_b32 v4, 31, v0
    v_lshrrev_b32 v5, 5, v0
    s_lshl_b32 s3, s4, 9
    v_lshl_add_u32 v6, v4, 4, s3
    s_lshl_b32 s3, s4, 6
    s_lshl_b32 s7, s5, 1
    s_add_u32 s36, s3, s7
    v_lshlrev_b32 v9, 4, v1
    s_mov_b32 s51, 1065369472
    s_lshl_b32 s26, s4, 8
    s_add_u32 s26, s26, 4194304
    s_lshl_b32 s3, s5, 3
    s_add_u32 s27, s26, s3
    v_mov_b32 v253, 0
    s_memrealtime s[56:57]
    s_waitcnt lgkmcnt(0)
    s_mov_b32 s28, s94
    s_mov_b32 s29, s95
    s_mov_b32 s30, 22020096
    s_mov_b32 s31, 0x20000
    s_mov_b32 s8, s66
    s_mov_b32 s9, s67
    s_mov_b32 s10, 2097152
    s_mov_b32 s11, 0x20000
    s_mov_b32 s12, s68
    s_mov_b32 s13, s69
    s_mov_b32 s14, 2097152
    s_mov_b32 s15, 0x20000
    s_add_u32 m0, s23, 102400
    s_nop 0
    buffer_load_dwordx4 v2, s[8:11], s20 offen nt lds
    s_add_u32 m0, s23, 110592
    s_nop 0
    buffer_load_dwordx4 v2, s[12:15], s20 offen nt lds
    s_cmp_lg_u32 s6, 1
    s_cbranch_scc1 adaLN_cond__ssm_conv_h3__mixer_s_mlp__prompt_kernel_ow1
    s_mov_b32 m0, 101376
    s_nop 0
    buffer_load_dwordx4 v8, s[8:11], 0 offen lds
adaLN_cond__ssm_conv_h3__mixer_s_mlp__prompt_kernel_ow1:
    s_mov_b32 s40, s92
    s_mov_b32 s41, s93
    s_mov_b32 s42, 256
    s_mov_b32 s43, 0x20000
    s_mov_b32 s16, s70
    s_mov_b32 s17, s71
    s_mov_b32 s18, 4096
    s_mov_b32 s19, 0x20000
    s_cmp_lg_u32 s6, 7
    s_cbranch_scc1 adaLN_cond__ssm_conv_h3__mixer_s_mlp__prompt_kernel_ow2
    s_cmp_lg_u32 s2, 0
    s_cbranch_scc1 adaLN_cond__ssm_conv_h3__mixer_s_mlp__prompt_kernel_ld3
    s_or_b32 s3, s56, 1
    v_mov_b32 v248, s3
    v_mov_b32 v249, s57
    s_mov_b64 s[46:47], exec
    s_mov_b64 exec, 1
    buffer_store_dwordx2 v[248:249], v253, s[40:43], 0 offen sc1
    s_mov_b64 exec, s[46:47]
adaLN_cond__ssm_conv_h3__mixer_s_mlp__prompt_kernel_ld3:
adaLN_cond__ssm_conv_h3__mixer_s_mlp__prompt_kernel_ow2:
    buffer_load_dwordx4 v[24:27], v6, s[16:19], 0 offen
    s_lshl_b32 s3, s36, 1
    s_load_dword s37, s[74:75], s3
    s_lshl_b32 s3, s36, 12
    s_add_u32 s32, s72, s3
    s_addc_u32 s33, s73, 0
    s_mov_b32 s34, 8192
    s_mov_b32 s35, 0x20000
    s_mov_b32 s16, s86
    s_mov_b32 s17, s87
    s_mov_b32 s18, 1024
    s_mov_b32 s19, 0x20000
    s_lshr_b32 s38, s6, 2
    s_mul_i32 s3, s38, 29184
    s_add_u32 s3, s3, s23
    s_add_u32 m0, s3, 63952
    v_lshlrev_b32 v44, 1, v0
    s_barrier
    s_cmp_lg_u32 s6, 4
    s_cbranch_scc1 adaLN_cond__ssm_conv_h3__mixer_s_mlp__prompt_kernel_ow4
    s_getpc_b64 s[46:47]
adaLN_cond__ssm_conv_h3__mixer_s_mlp__prompt_kernel_pc5:
    s_add_u32 s46, s46, adaLN_cond__ssm_conv_h3__mixer_s_mlp__prompt_kernel-adaLN_cond__ssm_conv_h3__mixer_s_mlp__prompt_kernel_pc5
    s_addc_u32 s47, s47, -1
    v_and_b32 v46, 15, v0
    s_lshl_b32 s3, s5, 4
    v_add_u32 v46, s3, v46
    v_lshlrev_b32 v46, 7, v46
    v_min_u32 v46, code_end-adaLN_cond__ssm_conv_h3__mixer_s_mlp__prompt_kernel-4, v46
    global_load_dword v47, v46, s[46:47]
adaLN_cond__ssm_conv_h3__mixer_s_mlp__prompt_kernel_ow4:
    buffer_load_dwordx4 v9, s[32:35], s23 offen nt lds
    buffer_load_ushort v45, v44, s[16:19], 0 offen
    v_lshrrev_b32 v163, 3, v0
    v_lshlrev_b32 v163, 15, v163
    v_and_b32 v30, 7, v0
    v_lshl_add_u32 v162, v30, 4, v163
    s_lshl_b32 s24, s36, 6
    s_add_u32 s24, s24, 2097152
    v_mov_b32 v28, -1
    v_mov_b32 v29, -1
    v_mov_b32 v30, -1
    v_mov_b32 v31, -1
    buffer_store_dwordx4 v[28:31], v162, s[28:31], s24 offen sc1
    s_cmp_lg_u32 s6, 5
    s_cbranch_scc1 adaLN_cond__ssm_conv_h3__mixer_s_mlp__prompt_kernel_ow6
    s_cmp_ge_u32 s5, 12
    s_cbranch_scc1 adaLN_cond__ssm_conv_h3__mixer_s_mlp__prompt_kernel_pfm7
    s_mul_i32 s3, s4, 12
    s_add_u32 s3, s3, s5
    s_lshl_b32 s3, s3, 7
    s_add_u32 s3, s3, 5177344
    v_and_b32 v32, 31, v1
    v_lshlrev_b32 v32, 2, v32
    buffer_store_dword v28, v32, s[28:31], s3 offen sc1
adaLN_cond__ssm_conv_h3__mixer_s_mlp__prompt_kernel_pfm7:
adaLN_cond__ssm_conv_h3__mixer_s_mlp__prompt_kernel_ow6:
    v_lshrrev_b32 v37, 3, v0
    v_and_b32 v38, 7, v0
    v_mul_u32_u24 v39, 144, v37
    v_lshl_add_u32 v39, v38, 4, v39
    v_lshrrev_b32 v165, 2, v0
    v_mul_u32_u24 v166, 6144, v165
    v_and_b32 v164, 3, v0
    v_lshl_add_u32 v166, v164, 4, v166
    v_lshlrev_b32 v165, 2, v165
    v_add_u32 v165, 122880, v165
    v_lshlrev_b32 v37, 12, v37
    v_lshl_add_u32 v37, v38, 4, v37
    s_lshl_b32 s48, s4, 18
    s_lshl_b32 s7, s5, 7
    s_sub_u32 s48, s48, s7
    s_add_u32 s48, s48, 3968
    s_lshl_b32 s49, s4, 5
    s_add_u32 s49, s49, s5
    s_lshl_b32 s39, s49, 3
    s_add_u32 s39, s39, s6
    s_mul_i32 s49, s4, 12
    s_add_u32 s49, s49, s5
    v_mul_u32_u24 v36, 288, v4
    v_lshlrev_b32 v38, 3, v5
    v_sub_u32 v36, v36, v38
    v_add_u32 v36, 120, v36
    v_lshlrev_b32 v2, 9, v5
    v_lshl_add_u32 v2, v4, 2, v2
    v_add_u32 v3, 110592, v2
    v_add_u32 v2, 102016, v2
    v_mov_b32 v116, 0
    v_mov_b32 v117, 0
    v_mov_b32 v118, 0
    v_mov_b32 v119, 0
    v_lshrrev_b32 v112, 5, v1
    v_mul_u32_u24 v112, 4608, v112
    v_and_b32 v113, 31, v1
    v_lshl_add_u32 v112, v113, 4, v112
    v_and_b32 v113, 15, v1
    v_mul_u32_u24 v113, 4160, v113
    v_lshlrev_b32 v167, 7, v1
    s_mov_b32 s8, s64
    s_mov_b32 s9, s65
    s_mov_b32 s10, 2097152
    s_mov_b32 s11, 0x20000
    s_mov_b32 s52, s88
    s_mov_b32 s53, s89
    s_mov_b32 s54, 3145728
    s_mov_b32 s55, 0x20000
    s_mov_b32 s56, s78
    s_mov_b32 s57, s79
    s_mov_b32 s58, 524288
    s_mov_b32 s59, 0x20000
    s_mov_b32 s60, s80
    s_mov_b32 s61, s81
    s_mov_b32 s62, 524288
    s_mov_b32 s63, 0x20000
    s_cmp_lg_u32 s6, 1
    s_cbranch_scc1 adaLN_cond__ssm_conv_h3__mixer_s_mlp__prompt_kernel_ow8
    ds_write_b128 v112, v[116:119] offset:29696
adaLN_cond__ssm_conv_h3__mixer_s_mlp__prompt_kernel_ow8:
    s_cmp_lg_u32 s6, 2
    s_cbranch_scc1 adaLN_cond__ssm_conv_h3__mixer_s_mlp__prompt_kernel_ow9
    ds_write_b128 v113, v[116:119] offset:34816
adaLN_cond__ssm_conv_h3__mixer_s_mlp__prompt_kernel_ow9:
    s_waitcnt vmcnt(3)
    s_barrier
    ds_read2_b32 v[10:11], v2 offset0:0 offset1:32
    ds_read2_b32 v[12:13], v2 offset0:64 offset1:96
    ds_read2_b32 v[14:15], v2 offset0:128 offset1:160
    ds_read_b32 v16, v2 offset:768
    ds_read2_b32 v[18:19], v3 offset0:0 offset1:32
    ds_read2_b32 v[20:21], v3 offset0:64 offset1:96
    s_cmp_lg_u32 s6, 0
    s_cbranch_scc1 adaLN_cond__ssm_conv_h3__mixer_s_mlp__prompt_kernel_ow10
    buffer_load_dwordx2 v[248:249], v253, s[40:43], 0 offen sc1
    v_and_b32 v252, 1, v1
    v_lshlrev_b32 v252, 7, v252
    v_and_b32 v251, 2, v1
    v_lshl_add_u32 v252, v251, 12, v252
    buffer_load_dword v251, v252, s[28:31], s26 offen sc1
adaLN_cond__ssm_conv_h3__mixer_s_mlp__prompt_kernel_ow10:
    v_lshlrev_b32 v62, 16, v24
    v_and_b32 v64, 0xffff0000, v24
    v_lshlrev_b32 v66, 16, v25
    v_and_b32 v68, 0xffff0000, v25
    v_lshlrev_b32 v63, 16, v26
    v_and_b32 v65, 0xffff0000, v26
    v_lshlrev_b32 v67, 16, v27
    v_and_b32 v69, 0xffff0000, v27
    s_waitcnt lgkmcnt(0)
    v_lshlrev_b32 v110, 16, v10
    v_and_b32 v111, 0xffff0000, v10
    v_lshlrev_b32 v112, 16, v11
    v_and_b32 v113, 0xffff0000, v11
    v_lshlrev_b32 v114, 16, v12
    v_and_b32 v115, 0xffff0000, v12
    v_lshlrev_b32 v116, 16, v13
    v_and_b32 v117, 0xffff0000, v13
    v_lshlrev_b32 v118, 16, v14
    v_and_b32 v119, 0xffff0000, v14
    v_lshlrev_b32 v120, 16, v15
    v_and_b32 v121, 0xffff0000, v15
    v_lshlrev_b32 v122, 16, v16
    v_and_b32 v123, 0xffff0000, v16
    v_pk_mul_f32 v[70:71], v[116:117], v[62:63]
    v_pk_mul_f32 v[72:73], v[118:119], v[62:63]
    v_pk_mul_f32 v[74:75], v[120:121], v[62:63]
    v_pk_mul_f32 v[76:77], v[122:123], v[62:63]
    v_pk_fma_f32 v[70:71], v[114:115], v[64:65], v[70:71]
    v_pk_fma_f32 v[72:73], v[116:117], v[64:65], v[72:73]
    v_pk_fma_f32 v[74:75], v[118:119], v[64:65], v[74:75]
    v_pk_fma_f32 v[76:77], v[120:121], v[64:65], v[76:77]
    v_pk_fma_f32 v[70:71], v[112:113], v[66:67], v[70:71]
    v_pk_fma_f32 v[72:73], v[114:115], v[66:67], v[72:73]
    v_pk_fma_f32 v[74:75], v[116:117], v[66:67], v[74:75]
    v_pk_fma_f32 v[76:77], v[118:119], v[66:67], v[76:77]
    v_pk_fma_f32 v[70:71], v[110:111], v[68:69], v[70:71]
    v_pk_fma_f32 v[72:73], v[112:113], v[68:69], v[72:73]
    v_pk_fma_f32 v[74:75], v[114:115], v[68:69], v[74:75]
    v_pk_fma_f32 v[76:77], v[116:117], v[68:69], v[76:77]
    v_lshlrev_b32 v54, 16, v18
    v_and_b32 v55, 0xffff0000, v18
    v_lshlrev_b32 v56, 16, v19
    v_and_b32 v57, 0xffff0000, v19
    v_lshlrev_b32 v58, 16, v20
    v_and_b32 v59, 0xffff0000, v20
    v_lshlrev_b32 v60, 16, v21
    v_and_b32 v61, 0xffff0000, v21
    v_pk_mul_f32 v[70:71], v[70:71], v[54:55]
    v_pk_mul_f32 v[72:73], v[72:73], v[56:57]
    v_pk_mul_f32 v[74:75], v[74:75], v[58:59]
    v_pk_mul_f32 v[76:77], v[76:77], v[60:61]
    v_cvt_pk_bf16_f32 v40, v76, v74
    v_cvt_pk_bf16_f32 v41, v72, v70
    v_cvt_pk_bf16_f32 v42, v77, v75
    v_cvt_pk_bf16_f32 v43, v73, v71
    ds_write_b64 v36, v[40:41]
    ds_write_b64 v36, v[42:43] offset:144
    s_waitcnt vmcnt(0) lgkmcnt(0)
    s_barrier
    ds_read_b128 v[40:43], v39 offset:0
    s_waitcnt lgkmcnt(0)
    buffer_store_dwordx4 v[40:43], v37, s[28:31], s48 offen sc1
    v_lshrrev_b32 v3, 8, v0
    v_mul_u32_u24 v3, 4608, v3
    v_and_b32 v4, 255, v0
    v_lshl_add_u32 v3, v4, 4, v3
    v_add_u32 v12, 25600, v3
    v_and_b32 v28, 15, v1
    v_lshrrev_b32 v29, 4, v1
    v_and_b32 v2, 7, v28
    v_mul_u32_u24 v2, 4160, v2
    v_lshrrev_b32 v3, 3, v28
    v_add_u32 v3, v3, v29
    v_lshl_add_u32 v2, v3, 4, v2
    s_mul_i32 s3, s38, 33280
    s_add_u32 s3, s3, 34816
    s_and_b32 s7, s6, 3
    s_lshl_b32 s7, s7, 7
    s_add_u32 s3, s3, s7
    v_add_u32 v2, s3, v2
    s_mul_i32 s3, s38, 4608
    s_add_u32 s3, s3, 26080
    v_lshlrev_b32 v3, 4, v29
    v_lshlrev_b32 v4, 5, v28
    v_sub_u32 v3, v3, v4
    v_add_u32 v3, s3, v3
    v_add_u32 v3, s7, v3
    s_add_u32 s3, s3, 24
    v_lshlrev_b32 v6, 3, v29
    v_add_u32 v6, v6, v4
    v_sub_u32 v6, s3, v6
    s_mul_i32 s3, s6, 6144
    s_add_u32 s3, s3, 34816
    v_lshl_add_u32 v4, v1, 4, s3
    s_mul_i32 s3, s38, 24576
    s_add_u32 s3, s3, 34816
    v_lshl_add_u32 v5, v1, 4, s3
    v_lshrrev_b32 v26, 1, v28
    v_lshlrev_b32 v26, 7, v26
    v_and_b32 v27, 1, v28
    v_lshl_add_u32 v26, v27, 5, v26
    v_lshl_add_u32 v26, v29, 3, v26
    s_lshl_b32 s3, s38, 6
    s_add_u32 s3, s3, 0
    v_add_u32 v26, s3, v26
    s_lshl_b32 s3, s37, 16
    s_and_b32 s7, s37, 0xffff0000
    s_cmp_eq_u32 s38, 0
    s_cselect_b32 s3, s3, s7
    v_mov_b32 v24, s3
    v_lshlrev_b32 v13, 4, v0
    s_lshl_b32 s20, s36, 12
    s_add_u32 s20, s20, 0
    v_add_u32 v14, 63936, v9
    v_add_u32 v15, 97216, v9
    s_cmp_eq_u32 s6, 1
    s_cbranch_scc1 adaLN_cond__ssm_conv_h3__mixer_s_mlp__prompt_kernel_cp1_13
    s_cmp_eq_u32 s6, 2
    s_cbranch_scc1 adaLN_cond__ssm_conv_h3__mixer_s_mlp__prompt_kernel_cp2_14
    s_cmp_eq_u32 s6, 3
    s_cbranch_scc1 adaLN_cond__ssm_conv_h3__mixer_s_mlp__prompt_kernel_cp3_15
    s_cmp_eq_u32 s6, 4
    s_cbranch_scc1 adaLN_cond__ssm_conv_h3__mixer_s_mlp__prompt_kernel_cp4_16
    s_cmp_eq_u32 s6, 5
    s_cbranch_scc1 adaLN_cond__ssm_conv_h3__mixer_s_mlp__prompt_kernel_cp5_17
    s_cmp_eq_u32 s6, 6
    s_cbranch_scc1 adaLN_cond__ssm_conv_h3__mixer_s_mlp__prompt_kernel_cp6_18
    s_cmp_eq_u32 s6, 7
    s_cbranch_scc1 adaLN_cond__ssm_conv_h3__mixer_s_mlp__prompt_kernel_cp7_19
    s_waitcnt vmcnt(0) lgkmcnt(0)
    s_barrier
    s_mov_b32 s45, 0
adaLN_cond__ssm_conv_h3__mixer_s_mlp__prompt_kernel_nn20:
    v_cmp_eq_u32 vcc, 0, v248
    s_cbranch_vccz adaLN_cond__ssm_conv_h3__mixer_s_mlp__prompt_kernel_nd21
    s_add_u32 s45, s45, 1
    s_cmp_gt_u32 s45, 2000000
    s_cbranch_scc1 adaLN_cond__ssm_conv_h3__mixer_s_mlp__prompt_kernel_nd21
    buffer_load_dwordx2 v[248:249], v253, s[40:43], 0 offen sc1
    s_waitcnt vmcnt(0)
    s_branch adaLN_cond__ssm_conv_h3__mixer_s_mlp__prompt_kernel_nn20
adaLN_cond__ssm_conv_h3__mixer_s_mlp__prompt_kernel_nd21:
    v_mov_b32 v252, s27
    s_mov_b64 s[46:47], exec
    s_mov_b64 exec, 1
    buffer_store_dwordx2 v[248:249], v252, s[28:31], 0 offen
    s_mov_b64 exec, s[46:47]
    s_mov_b32 s44, 1
    v_mov_b32 v252, 163832
    ds_write_b64 v252, v[248:249]
    v_min_u32 v252, 31, v1
    v_lshlrev_b32 v252, 3, v252
    s_mov_b32 s45, 0
adaLN_cond__ssm_conv_h3__mixer_s_mlp__prompt_kernel_pl22:
    buffer_load_dwordx2 v[250:251], v252, s[28:31], s26 offen sc1
    s_waitcnt vmcnt(0)
    v_cmp_ne_u64 vcc, v[248:249], v[250:251]
    s_cbranch_vccz adaLN_cond__ssm_conv_h3__mixer_s_mlp__prompt_kernel_ple23
    s_add_u32 s45, s45, 1
    s_cmp_lt_u32 s45, 48
    s_cbranch_scc1 adaLN_cond__ssm_conv_h3__mixer_s_mlp__prompt_kernel_pl22
    s_mov_b64 s[40:41], vcc
    s_cmp_eq_u32 s44, 0
    s_cbranch_scc1 adaLN_cond__ssm_conv_h3__mixer_s_mlp__prompt_kernel_gf25
    s_lshl_b32 s3, s4, 5
    s_add_u32 s3, s3, s5
    s_lshl_b32 s3, s3, 7
    s_add_u32 s3, s3, 4259840
    v_lshlrev_b32 v253, 3, v1
    s_mov_b64 s[46:47], exec
    s_mov_b64 exec, 0xffff
    buffer_store_dwordx2 v[248:249], v253, s[28:31], s3 offen sc1
    s_mov_b64 exec, s[46:47]
    s_mov_b32 s44, 0
adaLN_cond__ssm_conv_h3__mixer_s_mlp__prompt_kernel_gf25:
    s_lshl_b32 s3, s4, 5
    s_lshl_b32 s3, s3, 7
    s_add_u32 s3, s3, 4259840
    v_lshlrev_b32 v253, 4, v252
    buffer_load_dwordx2 v[250:251], v253, s[28:31], s3 offen sc1
    s_waitcnt vmcnt(0)
    v_cmp_ne_u64 vcc, v[248:249], v[250:251]
    s_nop 0
    s_and_b64 vcc, vcc, s[40:41]
    s_cbranch_vccz adaLN_cond__ssm_conv_h3__mixer_s_mlp__prompt_kernel_ple23
    s_cmp_lt_u32 s45, 2000000
    s_cbranch_scc1 adaLN_cond__ssm_conv_h3__mixer_s_mlp__prompt_kernel_pl22
adaLN_cond__ssm_conv_h3__mixer_s_mlp__prompt_kernel_ple23:
    s_waitcnt lgkmcnt(0)
    s_branch adaLN_cond__ssm_conv_h3__mixer_s_mlp__prompt_kernel_cj11
adaLN_cond__ssm_conv_h3__mixer_s_mlp__prompt_kernel_cp1_13:
    v_add_u32 v16, 34832, v9
    v_add_u32 v17, 68112, v9
    ds_read_b128 v[48:51], v14 offset:0
    ds_read_b128 v[52:55], v14 offset:16
    ds_read_b128 v[56:59], v14 offset:1024
    ds_read_b128 v[60:63], v14 offset:1040
    ds_read_b128 v[64:67], v14 offset:2048
    ds_read_b128 v[68:71], v14 offset:2064
    ds_read_b128 v[72:75], v14 offset:3072
    ds_read_b128 v[76:79], v14 offset:3088
    ds_read_b128 v[80:83], v15 offset:0
    ds_read_b128 v[84:87], v15 offset:16
    ds_read_b128 v[88:91], v15 offset:1024
    ds_read_b128 v[92:95], v15 offset:1040
    ds_read_b128 v[96:99], v15 offset:2048
    ds_read_b128 v[100:103], v15 offset:2064
    s_waitcnt lgkmcnt(8)
    ds_read_b128 v[104:107], v15 offset:3072
    ds_read_b128 v[108:111], v15 offset:3088
    s_waitcnt lgkmcnt(8)
    v_alignbit_b32 v116, v49, v48, 16
    v_alignbit_b32 v117, v50, v49, 16
    v_alignbit_b32 v118, v51, v50, 16
    v_alignbit_b32 v119, v52, v51, 16
    ds_write_b128 v16, v[116:119] offset:0
    v_alignbit_b32 v120, v57, v56, 16
    v_alignbit_b32 v121, v58, v57, 16
    v_alignbit_b32 v122, v59, v58, 16
    v_alignbit_b32 v123, v60, v59, 16
    ds_write_b128 v16, v[120:123] offset:1024
    s_waitcnt vmcnt(0)
    s_barrier
    v_alignbit_b32 v116, v65, v64, 16
    v_alignbit_b32 v117, v66, v65, 16
    v_alignbit_b32 v118, v67, v66, 16
    v_alignbit_b32 v119, v68, v67, 16
    ds_write_b128 v16, v[116:119] offset:2048
    v_alignbit_b32 v120, v73, v72, 16
    v_alignbit_b32 v121, v74, v73, 16
    v_alignbit_b32 v122, v75, v74, 16
    v_alignbit_b32 v123, v76, v75, 16
    ds_write_b128 v16, v[120:123] offset:3072
    s_waitcnt lgkmcnt(4)
    v_alignbit_b32 v116, v81, v80, 16
    v_alignbit_b32 v117, v82, v81, 16
    v_alignbit_b32 v118, v83, v82, 16
    v_alignbit_b32 v119, v84, v83, 16
    ds_write_b128 v17, v[116:119] offset:0
    v_alignbit_b32 v120, v89, v88, 16
    v_alignbit_b32 v121, v90, v89, 16
    v_alignbit_b32 v122, v91, v90, 16
    v_alignbit_b32 v123, v92, v91, 16
    ds_write_b128 v17, v[120:123] offset:1024
    v_alignbit_b32 v116, v97, v96, 16
    v_alignbit_b32 v117, v98, v97, 16
    v_alignbit_b32 v118, v99, v98, 16
    v_alignbit_b32 v119, v100, v99, 16
    ds_write_b128 v17, v[116:119] offset:2048
    v_alignbit_b32 v120, v105, v104, 16
    v_alignbit_b32 v121, v106, v105, 16
    v_alignbit_b32 v122, v107, v106, 16
    v_alignbit_b32 v123, v108, v107, 16
    ds_write_b128 v17, v[120:123] offset:3072
    s_branch adaLN_cond__ssm_conv_h3__mixer_s_mlp__prompt_kernel_cj11
adaLN_cond__ssm_conv_h3__mixer_s_mlp__prompt_kernel_cp2_14:
    v_add_u32 v16, 38992, v9
    v_add_u32 v17, 72272, v9
    ds_read_b128 v[48:51], v14 offset:0
    ds_read_b128 v[52:55], v14 offset:16
    ds_read_b128 v[56:59], v14 offset:1024
    ds_read_b128 v[60:63], v14 offset:1040
    ds_read_b128 v[64:67], v14 offset:2048
    ds_read_b128 v[68:71], v14 offset:2064
    ds_read_b128 v[72:75], v14 offset:3072
    ds_read_b128 v[76:79], v14 offset:3088
    ds_read_b128 v[80:83], v15 offset:0
    ds_read_b128 v[84:87], v15 offset:16
    ds_read_b128 v[88:91], v15 offset:1024
    ds_read_b128 v[92:95], v15 offset:1040
    ds_read_b128 v[96:99], v15 offset:2048
    ds_read_b128 v[100:103], v15 offset:2064
    s_waitcnt lgkmcnt(8)
    ds_read_b128 v[104:107], v15 offset:3072
    ds_read_b128 v[108:111], v15 offset:3088
    s_waitcnt lgkmcnt(8)
    v_mov_b32 v116, v49
    v_mov_b32 v117, v50
    v_mov_b32 v118, v51
    v_mov_b32 v119, v52
    ds_write_b128 v16, v[116:119] offset:0
    v_mov_b32 v120, v57
    v_mov_b32 v121, v58
    v_mov_b32 v122, v59
    v_mov_b32 v123, v60
    ds_write_b128 v16, v[120:123] offset:1024
    s_waitcnt vmcnt(0)
    s_barrier
    v_mov_b32 v116, v65
    v_mov_b32 v117, v66
    v_mov_b32 v118, v67
    v_mov_b32 v119, v68
    ds_write_b128 v16, v[116:119] offset:2048
    v_mov_b32 v120, v73
    v_mov_b32 v121, v74
    v_mov_b32 v122, v75
    v_mov_b32 v123, v76
    ds_write_b128 v16, v[120:123] offset:3072
    s_waitcnt lgkmcnt(4)
    v_mov_b32 v116, v81
    v_mov_b32 v117, v82
    v_mov_b32 v118, v83
    v_mov_b32 v119, v84
    ds_write_b128 v17, v[116:119] offset:0
    v_mov_b32 v120, v89
    v_mov_b32 v121, v90
    v_mov_b32 v122, v91
    v_mov_b32 v123, v92
    ds_write_b128 v17, v[120:123] offset:1024
    v_mov_b32 v116, v97
    v_mov_b32 v117, v98
    v_mov_b32 v118, v99
    v_mov_b32 v119, v100
    ds_write_b128 v17, v[116:119] offset:2048
    v_mov_b32 v120, v105
    v_mov_b32 v121, v106
    v_mov_b32 v122, v107
    v_mov_b32 v123, v108
    ds_write_b128 v17, v[120:123] offset:3072
    s_branch adaLN_cond__ssm_conv_h3__mixer_s_mlp__prompt_kernel_cj11
adaLN_cond__ssm_conv_h3__mixer_s_mlp__prompt_kernel_cp3_15:
    v_add_u32 v16, 43152, v9
    v_add_u32 v17, 76432, v9
    ds_read_b128 v[48:51], v14 offset:0
    ds_read_b128 v[52:55], v14 offset:16
    ds_read_b128 v[56:59], v14 offset:1024
    ds_read_b128 v[60:63], v14 offset:1040
    ds_read_b128 v[64:67], v14 offset:2048
    ds_read_b128 v[68:71], v14 offset:2064
    ds_read_b128 v[72:75], v14 offset:3072
    ds_read_b128 v[76:79], v14 offset:3088
    ds_read_b128 v[80:83], v15 offset:0
    ds_read_b128 v[84:87], v15 offset:16
    ds_read_b128 v[88:91], v15 offset:1024
    ds_read_b128 v[92:95], v15 offset:1040
    ds_read_b128 v[96:99], v15 offset:2048
    ds_read_b128 v[100:103], v15 offset:2064
    s_waitcnt lgkmcnt(8)
    ds_read_b128 v[104:107], v15 offset:3072
    ds_read_b128 v[108:111], v15 offset:3088
    s_waitcnt lgkmcnt(8)
    v_alignbit_b32 v116, v50, v49, 16
    v_alignbit_b32 v117, v51, v50, 16
    v_alignbit_b32 v118, v52, v51, 16
    v_alignbit_b32 v119, v53, v52, 16
    ds_write_b128 v16, v[116:119] offset:0
    v_alignbit_b32 v120, v58, v57, 16
    v_alignbit_b32 v121, v59, v58, 16
    v_alignbit_b32 v122, v60, v59, 16
    v_alignbit_b32 v123, v61, v60, 16
    ds_write_b128 v16, v[120:123] offset:1024
    s_waitcnt vmcnt(0)
    s_barrier
    v_alignbit_b32 v116, v66, v65, 16
    v_alignbit_b32 v117, v67, v66, 16
    v_alignbit_b32 v118, v68, v67, 16
    v_alignbit_b32 v119, v69, v68, 16
    ds_write_b128 v16, v[116:119] offset:2048
    v_alignbit_b32 v120, v74, v73, 16
    v_alignbit_b32 v121, v75, v74, 16
    v_alignbit_b32 v122, v76, v75, 16
    v_alignbit_b32 v123, v77, v76, 16
    ds_write_b128 v16, v[120:123] offset:3072
    s_waitcnt lgkmcnt(4)
    v_alignbit_b32 v116, v82, v81, 16
    v_alignbit_b32 v117, v83, v82, 16
    v_alignbit_b32 v118, v84, v83, 16
    v_alignbit_b32 v119, v85, v84, 16
    ds_write_b128 v17, v[116:119] offset:0
    v_alignbit_b32 v120, v90, v89, 16
    v_alignbit_b32 v121, v91, v90, 16
    v_alignbit_b32 v122, v92, v91, 16
    v_alignbit_b32 v123, v93, v92, 16
    ds_write_b128 v17, v[120:123] offset:1024
    v_alignbit_b32 v116, v98, v97, 16
    v_alignbit_b32 v117, v99, v98, 16
    v_alignbit_b32 v118, v100, v99, 16
    v_alignbit_b32 v119, v101, v100, 16
    ds_write_b128 v17, v[116:119] offset:2048
    v_alignbit_b32 v120, v106, v105, 16
    v_alignbit_b32 v121, v107, v106, 16
    v_alignbit_b32 v122, v108, v107, 16
    v_alignbit_b32 v123, v109, v108, 16
    ds_write_b128 v17, v[120:123] offset:3072
    s_branch adaLN_cond__ssm_conv_h3__mixer_s_mlp__prompt_kernel_cj11
adaLN_cond__ssm_conv_h3__mixer_s_mlp__prompt_kernel_cp4_16:
    v_add_u32 v16, 47312, v9
    v_add_u32 v17, 80592, v9
    ds_read_b128 v[48:51], v14 offset:0
    ds_read_b128 v[52:55], v14 offset:16
    ds_read_b128 v[56:59], v14 offset:1024
    ds_read_b128 v[60:63], v14 offset:1040
    ds_read_b128 v[64:67], v14 offset:2048
    ds_read_b128 v[68:71], v14 offset:2064
    ds_read_b128 v[72:75], v14 offset:3072
    ds_read_b128 v[76:79], v14 offset:3088
    ds_read_b128 v[80:83], v15 offset:0
    ds_read_b128 v[84:87], v15 offset:16
    ds_read_b128 v[88:91], v15 offset:1024
    ds_read_b128 v[92:95], v15 offset:1040
    ds_read_b128 v[96:99], v15 offset:2048
    ds_read_b128 v[100:103], v15 offset:2064
    s_waitcnt lgkmcnt(8)
    ds_read_b128 v[104:107], v15 offset:3072
    ds_read_b128 v[108:111], v15 offset:3088
    s_waitcnt lgkmcnt(8)
    ds_write_b128 v16, v[50:53] offset:0
    ds_write_b128 v16, v[58:61] offset:1024
    s_waitcnt vmcnt(0)
    s_barrier
    ds_write_b128 v16, v[66:69] offset:2048
    ds_write_b128 v16, v[74:77] offset:3072
    s_waitcnt lgkmcnt(4)
    ds_write_b128 v17, v[82:85] offset:0
    ds_write_b128 v17, v[90:93] offset:1024
    ds_write_b128 v17, v[98:101] offset:2048
    ds_write_b128 v17, v[106:109] offset:3072
    s_branch adaLN_cond__ssm_conv_h3__mixer_s_mlp__prompt_kernel_cj11
adaLN_cond__ssm_conv_h3__mixer_s_mlp__prompt_kernel_cp5_17:
    v_add_u32 v16, 51472, v9
    v_add_u32 v17, 84752, v9
    ds_read_b128 v[48:51], v14 offset:0
    ds_read_b128 v[52:55], v14 offset:16
    ds_read_b128 v[56:59], v14 offset:1024
    ds_read_b128 v[60:63], v14 offset:1040
    ds_read_b128 v[64:67], v14 offset:2048
    ds_read_b128 v[68:71], v14 offset:2064
    ds_read_b128 v[72:75], v14 offset:3072
    ds_read_b128 v[76:79], v14 offset:3088
    ds_read_b128 v[80:83], v15 offset:0
    ds_read_b128 v[84:87], v15 offset:16
    ds_read_b128 v[88:91], v15 offset:1024
    ds_read_b128 v[92:95], v15 offset:1040
    ds_read_b128 v[96:99], v15 offset:2048
    ds_read_b128 v[100:103], v15 offset:2064
    s_waitcnt lgkmcnt(8)
    ds_read_b128 v[104:107], v15 offset:3072
    ds_read_b128 v[108:111], v15 offset:3088
    s_waitcnt lgkmcnt(8)
    v_alignbit_b32 v116, v51, v50, 16
    v_alignbit_b32 v117, v52, v51, 16
    v_alignbit_b32 v118, v53, v52, 16
    v_alignbit_b32 v119, v54, v53, 16
    ds_write_b128 v16, v[116:119] offset:0
    v_alignbit_b32 v120, v59, v58, 16
    v_alignbit_b32 v121, v60, v59, 16
    v_alignbit_b32 v122, v61, v60, 16
    v_alignbit_b32 v123, v62, v61, 16
    ds_write_b128 v16, v[120:123] offset:1024
    s_waitcnt vmcnt(0)
    s_barrier
    v_alignbit_b32 v116, v67, v66, 16
    v_alignbit_b32 v117, v68, v67, 16
    v_alignbit_b32 v118, v69, v68, 16
    v_alignbit_b32 v119, v70, v69, 16
    ds_write_b128 v16, v[116:119] offset:2048
    v_alignbit_b32 v120, v75, v74, 16
    v_alignbit_b32 v121, v76, v75, 16
    v_alignbit_b32 v122, v77, v76, 16
    v_alignbit_b32 v123, v78, v77, 16
    ds_write_b128 v16, v[120:123] offset:3072
    s_waitcnt lgkmcnt(4)
    v_alignbit_b32 v116, v83, v82, 16
    v_alignbit_b32 v117, v84, v83, 16
    v_alignbit_b32 v118, v85, v84, 16
    v_alignbit_b32 v119, v86, v85, 16
    ds_write_b128 v17, v[116:119] offset:0
    v_alignbit_b32 v120, v91, v90, 16
    v_alignbit_b32 v121, v92, v91, 16
    v_alignbit_b32 v122, v93, v92, 16
    v_alignbit_b32 v123, v94, v93, 16
    ds_write_b128 v17, v[120:123] offset:1024
    v_alignbit_b32 v116, v99, v98, 16
    v_alignbit_b32 v117, v100, v99, 16
    v_alignbit_b32 v118, v101, v100, 16
    v_alignbit_b32 v119, v102, v101, 16
    ds_write_b128 v17, v[116:119] offset:2048
    v_alignbit_b32 v120, v107, v106, 16
    v_alignbit_b32 v121, v108, v107, 16
    v_alignbit_b32 v122, v109, v108, 16
    v_alignbit_b32 v123, v110, v109, 16
    ds_write_b128 v17, v[120:123] offset:3072
    s_branch adaLN_cond__ssm_conv_h3__mixer_s_mlp__prompt_kernel_cj11
adaLN_cond__ssm_conv_h3__mixer_s_mlp__prompt_kernel_cp6_18:
    v_add_u32 v16, 55632, v9
    v_add_u32 v17, 88912, v9
    ds_read_b128 v[48:51], v14 offset:0
    ds_read_b128 v[52:55], v14 offset:16
    ds_read_b128 v[56:59], v14 offset:1024
    ds_read_b128 v[60:63], v14 offset:1040
    ds_read_b128 v[64:67], v14 offset:2048
    ds_read_b128 v[68:71], v14 offset:2064
    ds_read_b128 v[72:75], v14 offset:3072
    ds_read_b128 v[76:79], v14 offset:3088
    ds_read_b128 v[80:83], v15 offset:0
    ds_read_b128 v[84:87], v15 offset:16
    ds_read_b128 v[88:91], v15 offset:1024
    ds_read_b128 v[92:95], v15 offset:1040
    ds_read_b128 v[96:99], v15 offset:2048
    ds_read_b128 v[100:103], v15 offset:2064
    s_waitcnt lgkmcnt(8)
    ds_read_b128 v[104:107], v15 offset:3072
    ds_read_b128 v[108:111], v15 offset:3088
    s_waitcnt lgkmcnt(8)
    v_mov_b32 v116, v51
    v_mov_b32 v117, v52
    v_mov_b32 v118, v53
    v_mov_b32 v119, v54
    ds_write_b128 v16, v[116:119] offset:0
    v_mov_b32 v120, v59
    v_mov_b32 v121, v60
    v_mov_b32 v122, v61
    v_mov_b32 v123, v62
    ds_write_b128 v16, v[120:123] offset:1024
    s_waitcnt vmcnt(0)
    s_barrier
    v_mov_b32 v116, v67
    v_mov_b32 v117, v68
    v_mov_b32 v118, v69
    v_mov_b32 v119, v70
    ds_write_b128 v16, v[116:119] offset:2048
    v_mov_b32 v120, v75
    v_mov_b32 v121, v76
    v_mov_b32 v122, v77
    v_mov_b32 v123, v78
    ds_write_b128 v16, v[120:123] offset:3072
    s_waitcnt lgkmcnt(4)
    v_mov_b32 v116, v83
    v_mov_b32 v117, v84
    v_mov_b32 v118, v85
    v_mov_b32 v119, v86
    ds_write_b128 v17, v[116:119] offset:0
    v_mov_b32 v120, v91
    v_mov_b32 v121, v92
    v_mov_b32 v122, v93
    v_mov_b32 v123, v94
    ds_write_b128 v17, v[120:123] offset:1024
    v_mov_b32 v116, v99
    v_mov_b32 v117, v100
    v_mov_b32 v118, v101
    v_mov_b32 v119, v102
    ds_write_b128 v17, v[116:119] offset:2048
    v_mov_b32 v120, v107
    v_mov_b32 v121, v108
    v_mov_b32 v122, v109
    v_mov_b32 v123, v110
    ds_write_b128 v17, v[120:123] offset:3072
    s_branch adaLN_cond__ssm_conv_h3__mixer_s_mlp__prompt_kernel_cj11
adaLN_cond__ssm_conv_h3__mixer_s_mlp__prompt_kernel_cp7_19:
    v_add_u32 v16, 59792, v9
    v_add_u32 v17, 93072, v9
    ds_read_b128 v[48:51], v14 offset:0
    ds_read_b128 v[52:55], v14 offset:16
    ds_read_b128 v[56:59], v14 offset:1024
    ds_read_b128 v[60:63], v14 offset:1040
    ds_read_b128 v[64:67], v14 offset:2048
    ds_read_b128 v[68:71], v14 offset:2064
    ds_read_b128 v[72:75], v14 offset:3072
    ds_read_b128 v[76:79], v14 offset:3088
    ds_read_b128 v[80:83], v15 offset:0
    ds_read_b128 v[84:87], v15 offset:16
    ds_read_b128 v[88:91], v15 offset:1024
    ds_read_b128 v[92:95], v15 offset:1040
    ds_read_b128 v[96:99], v15 offset:2048
    ds_read_b128 v[100:103], v15 offset:2064
    s_waitcnt lgkmcnt(8)
    ds_read_b128 v[104:107], v15 offset:3072
    ds_read_b128 v[108:111], v15 offset:3088
    s_waitcnt lgkmcnt(8)
    v_alignbit_b32 v116, v52, v51, 16
    v_alignbit_b32 v117, v53, v52, 16
    v_alignbit_b32 v118, v54, v53, 16
    v_alignbit_b32 v119, v55, v54, 16
    ds_write_b128 v16, v[116:119] offset:0
    v_alignbit_b32 v120, v60, v59, 16
    v_alignbit_b32 v121, v61, v60, 16
    v_alignbit_b32 v122, v62, v61, 16
    v_alignbit_b32 v123, v63, v62, 16
    ds_write_b128 v16, v[120:123] offset:1024
    s_waitcnt vmcnt(0)
    s_barrier
    v_alignbit_b32 v116, v68, v67, 16
    v_alignbit_b32 v117, v69, v68, 16
    v_alignbit_b32 v118, v70, v69, 16
    v_alignbit_b32 v119, v71, v70, 16
    ds_write_b128 v16, v[116:119] offset:2048
    v_alignbit_b32 v120, v76, v75, 16
    v_alignbit_b32 v121, v77, v76, 16
    v_alignbit_b32 v122, v78, v77, 16
    v_alignbit_b32 v123, v79, v78, 16
    ds_write_b128 v16, v[120:123] offset:3072
    s_waitcnt lgkmcnt(4)
    v_alignbit_b32 v116, v84, v83, 16
    v_alignbit_b32 v117, v85, v84, 16
    v_alignbit_b32 v118, v86, v85, 16
    v_alignbit_b32 v119, v87, v86, 16
    ds_write_b128 v17, v[116:119] offset:0
    v_alignbit_b32 v120, v92, v91, 16
    v_alignbit_b32 v121, v93, v92, 16
    v_alignbit_b32 v122, v94, v93, 16
    v_alignbit_b32 v123, v95, v94, 16
    ds_write_b128 v17, v[120:123] offset:1024
    v_alignbit_b32 v116, v100, v99, 16
    v_alignbit_b32 v117, v101, v100, 16
    v_alignbit_b32 v118, v102, v101, 16
    v_alignbit_b32 v119, v103, v102, 16
    ds_write_b128 v17, v[116:119] offset:2048
    v_alignbit_b32 v120, v108, v107, 16
    v_alignbit_b32 v121, v109, v108, 16
    v_alignbit_b32 v122, v110, v109, 16
    v_alignbit_b32 v123, v111, v110, 16
    ds_write_b128 v17, v[120:123] offset:3072
adaLN_cond__ssm_conv_h3__mixer_s_mlp__prompt_kernel_cj11:
    s_barrier
    buffer_load_dwordx4 v[20:23], v13, s[28:31], s20 offen sc1
    v_mov_b32 v252, 163832
    ds_read_b64 v[248:249], v252
    v_lshlrev_b32 v45, 16, v45
    v_mul_f32 v46, 0xbfb8aa3b, v45
    v_exp_f32 v46, v46
    s_nop 0
    v_add_f32 v46, 1.0, v46
    v_rcp_f32 v46, v46
    s_nop 0
    v_mul_f32 v45, v45, v46
    v_cvt_pk_bf16_f32 v45, v45, v45
    v_lshlrev_b32 v45, 16, v45
    v_lshlrev_b32 v44, 2, v0
    v_add_u32 v44, 122880, v44
    ds_write_b32 v44, v45 offset:0
    s_barrier
    s_lshl_b32 s21, s49, 6
    s_cmp_ge_u32 s5, 12
    s_cbranch_scc1 adaLN_cond__ssm_conv_h3__mixer_s_mlp__prompt_kernel_mw26
    s_waitcnt vmcnt(0)
    s_branch adaLN_cond__ssm_conv_h3__mixer_s_mlp__prompt_kernel_mn27
adaLN_cond__ssm_conv_h3__mixer_s_mlp__prompt_kernel_mw26:
    s_sub_u32 s3, s5, 12
    s_mul_i32 s7, s6, 20
    s_add_u32 s3, s3, s7
    s_cmp_ge_u32 s3, 48
    s_cbranch_scc1 adaLN_cond__ssm_conv_h3__mixer_s_mlp__prompt_kernel_mw26a
    s_lshr_b32 s7, s3, 3
    s_mul_i32 s46, s4, 6
    s_add_u32 s7, s7, s46
    s_lshl_b32 s7, s7, 7
    s_and_b32 s3, s3, 7
    s_mul_i32 s3, s3, 393216
    s_add_u32 s3, s3, s7
    v_mul_u32_u24 v174, 6144, v1
    buffer_load_dword v175, v174, s[52:55], s3 offen
    s_branch adaLN_cond__ssm_conv_h3__mixer_s_mlp__prompt_kernel_mw26z
adaLN_cond__ssm_conv_h3__mixer_s_mlp__prompt_kernel_mw26a:
    s_sub_u32 s3, s3, 48
    s_lshl_b32 s3, s3, 13
    s_cmp_ge_u32 s3, 0x80000
    s_cbranch_scc1 adaLN_cond__ssm_conv_h3__mixer_s_mlp__prompt_kernel_mw26b
    buffer_load_dword v175, v167, s[56:59], s3 offen
    s_branch adaLN_cond__ssm_conv_h3__mixer_s_mlp__prompt_kernel_mw26z
adaLN_cond__ssm_conv_h3__mixer_s_mlp__prompt_kernel_mw26b:
    s_sub_u32 s3, s3, 0x80000
    buffer_load_dword v175, v167, s[60:63], s3 offen
adaLN_cond__ssm_conv_h3__mixer_s_mlp__prompt_kernel_mw26z:
    s_waitcnt vmcnt(1)
adaLN_cond__ssm_conv_h3__mixer_s_mlp__prompt_kernel_mn27:
    ds_write_b128 v12, v[20:23]
    s_waitcnt lgkmcnt(1)
    s_cmp_lg_u32 s6, 0
    s_cbranch_scc1 adaLN_cond__ssm_conv_h3__mixer_s_mlp__prompt_kernel_ow28
    s_cmp_eq_u32 s44, 0
    s_cbranch_scc1 adaLN_cond__ssm_conv_h3__mixer_s_mlp__prompt_kernel_gf29
    s_lshl_b32 s3, s4, 5
    s_add_u32 s3, s3, s5
    s_lshl_b32 s3, s3, 7
    s_add_u32 s3, s3, 4259840
    v_lshlrev_b32 v253, 3, v1
    s_mov_b64 s[46:47], exec
    s_mov_b64 exec, 0xffff
    buffer_store_dwordx2 v[248:249], v253, s[28:31], s3 offen sc1
    s_mov_b64 exec, s[46:47]
    s_mov_b32 s44, 0
adaLN_cond__ssm_conv_h3__mixer_s_mlp__prompt_kernel_gf29:
    s_cmp_lg_u32 s5, 31
    s_cbranch_scc1 adaLN_cond__ssm_conv_h3__mixer_s_mlp__prompt_kernel_gg30
    s_lshl_b32 s3, s4, 7
    s_add_u32 s3, s3, 4489216
    v_lshlrev_b32 v253, 3, v1
    s_mov_b64 s[46:47], exec
    s_mov_b64 exec, 0xffff
    buffer_store_dwordx2 v[248:249], v253, s[28:31], s3 offen sc1
    s_mov_b64 exec, s[46:47]
adaLN_cond__ssm_conv_h3__mixer_s_mlp__prompt_kernel_gg30:
adaLN_cond__ssm_conv_h3__mixer_s_mlp__prompt_kernel_ow28:
    s_waitcnt lgkmcnt(0)
    s_barrier
    ds_read_b128 v[32:35], v2 offset:0
    ds_read_b128 v[64:67], v3 offset:3584
    ds_read_b128 v[36:39], v2 offset:512
    ds_read_b128 v[68:71], v3 offset:3072
    ds_read_b128 v[72:75], v3 offset:2560
    ds_read_b128 v[40:43], v2 offset:1024
    ds_read_b128 v[76:79], v3 offset:2048
    ds_read_b128 v[44:47], v2 offset:1536
    ds_read_b128 v[48:51], v2 offset:2048
    ds_read_b128 v[80:83], v3 offset:1536
    ds_read_b128 v[52:55], v2 offset:2560
    ds_read_b128 v[84:87], v3 offset:1024
    s_waitcnt lgkmcnt(10)
    v_mfma_f32_16x16x32_bf16 v[208:211], v[32:35], v[64:67], 0
    ds_read_b128 v[88:91], v3 offset:512
    s_waitcnt lgkmcnt(10)
    v_mfma_f32_16x16x32_bf16 v[212:215], v[36:39], v[64:67], 0
    ds_read_b128 v[56:59], v2 offset:3072
    s_waitcnt lgkmcnt(10)
    v_mfma_f32_16x16x32_bf16 v[212:215], v[32:35], v[68:71], v[212:215]
    ds_read_b128 v[92:95], v3 offset:0
    s_waitcnt lgkmcnt(11)
    v_mfma_f32_16x16x32_bf16 v[216:219], v[36:39], v[68:71], 0
    ds_read_b128 v[60:63], v2 offset:3584
    s_waitcnt lgkmcnt(11)
    v_mfma_f32_16x16x32_bf16 v[216:219], v[32:35], v[72:75], v[216:219]
    ds_read_b128 v[96:99], v2 offset:64
    s_waitcnt lgkmcnt(11)
    v_mfma_f32_16x16x32_bf16 v[216:219], v[40:43], v[64:67], v[216:219]
    ds_read_b128 v[128:131], v3 offset:3648
    s_waitcnt lgkmcnt(13)
    v_mfma_f32_16x16x32_bf16 v[220:223], v[36:39], v[72:75], 0
    ds_read_b128 v[100:103], v2 offset:576
    s_waitcnt lgkmcnt(13)
    v_mfma_f32_16x16x32_bf16 v[220:223], v[40:43], v[68:71], v[220:223]
    ds_read_b128 v[132:135], v3 offset:3136
    s_waitcnt lgkmcnt(14)
    v_mfma_f32_16x16x32_bf16 v[224:227], v[40:43], v[72:75], 0
    s_waitcnt lgkmcnt(13)
    ds_read_b128 v[136:139], v3 offset:2624
    s_waitcnt lgkmcnt(14)
    v_mfma_f32_16x16x32_bf16 v[220:223], v[32:35], v[76:79], v[220:223]
    s_waitcnt lgkmcnt(13)
    v_mfma_f32_16x16x32_bf16 v[220:223], v[44:47], v[64:67], v[220:223]
    ds_read_b128 v[104:107], v2 offset:1088
    s_waitcnt lgkmcnt(14)
    v_mfma_f32_16x16x32_bf16 v[224:227], v[44:47], v[68:71], v[224:227]
    v_mfma_f32_16x16x32_bf16 v[224:227], v[36:39], v[76:79], v[224:227]
    s_waitcnt lgkmcnt(13)
    ds_read_b128 v[140:143], v3 offset:2112
    v_mfma_f32_16x16x32_bf16 v[228:231], v[40:43], v[76:79], 0
    v_mfma_f32_16x16x32_bf16 v[228:231], v[44:47], v[72:75], v[228:231]
    s_waitcnt lgkmcnt(13)
    ds_read_b128 v[108:111], v2 offset:1600
    v_mfma_f32_16x16x32_bf16 v[232:235], v[44:47], v[76:79], 0
    v_mfma_f32_16x16x32_bf16 v[224:227], v[48:51], v[64:67], v[224:227]
    s_waitcnt lgkmcnt(13)
    ds_read_b128 v[112:115], v2 offset:2112
    v_mfma_f32_16x16x32_bf16 v[224:227], v[32:35], v[80:83], v[224:227]
    v_mfma_f32_16x16x32_bf16 v[228:231], v[48:51], v[68:71], v[228:231]
    s_waitcnt lgkmcnt(13)
    ds_read_b128 v[144:147], v3 offset:1600
    v_mfma_f32_16x16x32_bf16 v[228:231], v[36:39], v[80:83], v[228:231]
    v_mfma_f32_16x16x32_bf16 v[232:235], v[40:43], v[80:83], v[232:235]
    s_waitcnt lgkmcnt(13)
    ds_read_b128 v[116:119], v2 offset:2624
    v_mfma_f32_16x16x32_bf16 v[232:235], v[48:51], v[72:75], v[232:235]
    v_mfma_f32_16x16x32_bf16 v[236:239], v[44:47], v[80:83], 0
    s_waitcnt lgkmcnt(13)
    ds_read_b128 v[148:151], v3 offset:1088
    v_mfma_f32_16x16x32_bf16 v[236:239], v[48:51], v[76:79], v[236:239]
    v_mfma_f32_16x16x32_bf16 v[228:231], v[52:55], v[64:67], v[228:231]
    s_waitcnt lgkmcnt(13)
    ds_read_b128 v[152:155], v3 offset:576
    v_mfma_f32_16x16x32_bf16 v[228:231], v[32:35], v[84:87], v[228:231]
    v_mfma_f32_16x16x32_bf16 v[232:235], v[52:55], v[68:71], v[232:235]
    s_waitcnt lgkmcnt(13)
    ds_read_b128 v[120:123], v2 offset:3136
    v_mfma_f32_16x16x32_bf16 v[232:235], v[36:39], v[84:87], v[232:235]
    v_mfma_f32_16x16x32_bf16 v[236:239], v[40:43], v[84:87], v[236:239]
    s_waitcnt lgkmcnt(13)
    ds_read_b128 v[156:159], v3 offset:64
    v_mfma_f32_16x16x32_bf16 v[236:239], v[52:55], v[72:75], v[236:239]
    v_mfma_f32_16x16x32_bf16 v[232:235], v[32:35], v[88:91], v[232:235]
    s_waitcnt lgkmcnt(13)
    ds_read_b128 v[124:127], v2 offset:3648
    v_mfma_f32_16x16x32_bf16 v[232:235], v[56:59], v[64:67], v[232:235]
    v_mfma_f32_16x16x32_bf16 v[236:239], v[56:59], v[68:71], v[236:239]
    v_mfma_f32_16x16x32_bf16 v[236:239], v[36:39], v[88:91], v[236:239]
    v_mfma_f32_16x16x32_bf16 v[236:239], v[32:35], v[92:95], v[236:239]
    v_mfma_f32_16x16x32_bf16 v[236:239], v[60:63], v[64:67], v[236:239]
    s_waitcnt lgkmcnt(14)
    v_mfma_f32_16x16x32_bf16 v[208:211], v[96:99], v[128:131], v[208:211]
    s_waitcnt lgkmcnt(13)
    v_mfma_f32_16x16x32_bf16 v[212:215], v[100:103], v[128:131], v[212:215]
    s_waitcnt lgkmcnt(12)
    v_mfma_f32_16x16x32_bf16 v[212:215], v[96:99], v[132:135], v[212:215]
    s_waitcnt lgkmcnt(12)
    v_mfma_f32_16x16x32_bf16 v[216:219], v[100:103], v[132:135], v[216:219]
    s_cmp_ge_u32 s5, 12
    s_cbranch_scc1 adaLN_cond__ssm_conv_h3__mixer_s_mlp__prompt_kernel_ml31
    buffer_load_dwordx4 v[176:179], v166, s[52:55], s21 offen
    s_add_u32 s21, s21, 786432
adaLN_cond__ssm_conv_h3__mixer_s_mlp__prompt_kernel_ml31:
    s_waitcnt lgkmcnt(11)
    v_mfma_f32_16x16x32_bf16 v[216:219], v[96:99], v[136:139], v[216:219]
    s_waitcnt lgkmcnt(10)
    v_mfma_f32_16x16x32_bf16 v[216:219], v[104:107], v[128:131], v[216:219]
    s_waitcnt lgkmcnt(11)
    v_mfma_f32_16x16x32_bf16 v[220:223], v[100:103], v[136:139], v[220:223]
    s_waitcnt lgkmcnt(10)
    v_mfma_f32_16x16x32_bf16 v[220:223], v[104:107], v[132:135], v[220:223]
    s_waitcnt lgkmcnt(10)
    v_mfma_f32_16x16x32_bf16 v[224:227], v[104:107], v[136:139], v[224:227]
    s_waitcnt lgkmcnt(9)
    v_mfma_f32_16x16x32_bf16 v[220:223], v[96:99], v[140:143], v[220:223]
    s_waitcnt lgkmcnt(8)
    v_mfma_f32_16x16x32_bf16 v[220:223], v[108:111], v[128:131], v[220:223]
    s_waitcnt lgkmcnt(8)
    v_mfma_f32_16x16x32_bf16 v[224:227], v[108:111], v[132:135], v[224:227]
    s_cmp_ge_u32 s5, 12
    s_cbranch_scc1 adaLN_cond__ssm_conv_h3__mixer_s_mlp__prompt_kernel_ml32
    buffer_load_dwordx4 v[180:183], v166, s[52:55], s21 offen
    s_add_u32 s21, s21, 786432
adaLN_cond__ssm_conv_h3__mixer_s_mlp__prompt_kernel_ml32:
    s_waitcnt lgkmcnt(9)
    v_mfma_f32_16x16x32_bf16 v[224:227], v[100:103], v[140:143], v[224:227]
    s_waitcnt lgkmcnt(9)
    v_mfma_f32_16x16x32_bf16 v[228:231], v[104:107], v[140:143], v[228:231]
    s_waitcnt lgkmcnt(8)
    v_mfma_f32_16x16x32_bf16 v[228:231], v[108:111], v[136:139], v[228:231]
    s_waitcnt lgkmcnt(8)
    v_mfma_f32_16x16x32_bf16 v[232:235], v[108:111], v[140:143], v[232:235]
    s_waitcnt lgkmcnt(7)
    v_mfma_f32_16x16x32_bf16 v[224:227], v[112:115], v[128:131], v[224:227]
    s_waitcnt lgkmcnt(6)
    v_mfma_f32_16x16x32_bf16 v[224:227], v[96:99], v[144:147], v[224:227]
    s_waitcnt lgkmcnt(7)
    v_mfma_f32_16x16x32_bf16 v[228:231], v[112:115], v[132:135], v[228:231]
    s_waitcnt lgkmcnt(6)
    v_mfma_f32_16x16x32_bf16 v[228:231], v[100:103], v[144:147], v[228:231]
    s_cmp_ge_u32 s5, 12
    s_cbranch_scc1 adaLN_cond__ssm_conv_h3__mixer_s_mlp__prompt_kernel_ml33
    buffer_load_dwordx4 v[184:187], v166, s[52:55], s21 offen
    s_add_u32 s21, s21, 786432
adaLN_cond__ssm_conv_h3__mixer_s_mlp__prompt_kernel_ml33:
    s_waitcnt lgkmcnt(6)
    v_mfma_f32_16x16x32_bf16 v[232:235], v[104:107], v[144:147], v[232:235]
    s_waitcnt lgkmcnt(7)
    v_mfma_f32_16x16x32_bf16 v[232:235], v[112:115], v[136:139], v[232:235]
    s_waitcnt lgkmcnt(6)
    v_mfma_f32_16x16x32_bf16 v[236:239], v[108:111], v[144:147], v[236:239]
    s_waitcnt lgkmcnt(7)
    v_mfma_f32_16x16x32_bf16 v[236:239], v[112:115], v[140:143], v[236:239]
    s_waitcnt lgkmcnt(5)
    v_mfma_f32_16x16x32_bf16 v[228:231], v[116:119], v[128:131], v[228:231]
    s_waitcnt lgkmcnt(4)
    v_mfma_f32_16x16x32_bf16 v[228:231], v[96:99], v[148:151], v[228:231]
    s_waitcnt lgkmcnt(5)
    v_mfma_f32_16x16x32_bf16 v[232:235], v[116:119], v[132:135], v[232:235]
    s_waitcnt lgkmcnt(4)
    v_mfma_f32_16x16x32_bf16 v[232:235], v[100:103], v[148:151], v[232:235]
    s_cmp_ge_u32 s5, 12
    s_cbranch_scc1 adaLN_cond__ssm_conv_h3__mixer_s_mlp__prompt_kernel_ml34
    buffer_load_dwordx4 v[188:191], v166, s[52:55], s21 offen
    s_add_u32 s21, s21, 786432
adaLN_cond__ssm_conv_h3__mixer_s_mlp__prompt_kernel_ml34:
    s_waitcnt lgkmcnt(4)
    v_mfma_f32_16x16x32_bf16 v[236:239], v[104:107], v[148:151], v[236:239]
    s_waitcnt lgkmcnt(5)
    v_mfma_f32_16x16x32_bf16 v[236:239], v[116:119], v[136:139], v[236:239]
    s_waitcnt lgkmcnt(3)
    v_mfma_f32_16x16x32_bf16 v[232:235], v[96:99], v[152:155], v[232:235]
    s_waitcnt lgkmcnt(2)
    v_mfma_f32_16x16x32_bf16 v[232:235], v[120:123], v[128:131], v[232:235]
    s_waitcnt lgkmcnt(2)
    v_mfma_f32_16x16x32_bf16 v[236:239], v[120:123], v[132:135], v[236:239]
    s_waitcnt lgkmcnt(3)
    v_mfma_f32_16x16x32_bf16 v[236:239], v[100:103], v[152:155], v[236:239]
    s_waitcnt lgkmcnt(1)
    v_mfma_f32_16x16x32_bf16 v[236:239], v[96:99], v[156:159], v[236:239]
    s_waitcnt lgkmcnt(0)
    v_mfma_f32_16x16x32_bf16 v[236:239], v[124:127], v[128:131], v[236:239]
    s_barrier
    s_nop 7
    s_and_b32 s3, s6, 3
    s_cmp_eq_u32 s3, 1
    s_cbranch_scc1 adaLN_cond__ssm_conv_h3__mixer_s_mlp__prompt_kernel_cv1_36
    s_cmp_eq_u32 s3, 2
    s_cbranch_scc1 adaLN_cond__ssm_conv_h3__mixer_s_mlp__prompt_kernel_cv2_37
    s_cmp_eq_u32 s3, 3
    s_cbranch_scc1 adaLN_cond__ssm_conv_h3__mixer_s_mlp__prompt_kernel_cv3_38
    ds_write_b128 v4, v[216:219] offset:0
    ds_write_b128 v4, v[220:223] offset:1024
    ds_write_b128 v4, v[224:227] offset:2048
    ds_write_b128 v4, v[228:231] offset:3072
    ds_write_b128 v4, v[232:235] offset:4096
    ds_write_b128 v4, v[236:239] offset:5120
    ds_read_b64 v[32:33], v6 offset:3584
    ds_read_b64 v[34:35], v6 offset:3072
    s_waitcnt lgkmcnt(0)
    s_barrier
    ds_read_b128 v[64:67], v5 offset:18432
    ds_read_b128 v[68:71], v5 offset:19456
    ds_read_b128 v[72:75], v5 offset:14336
    ds_read_b128 v[76:79], v5 offset:15360
    ds_read_b128 v[80:83], v5 offset:10240
    ds_read_b128 v[84:87], v5 offset:11264
    v_lshlrev_b32 v51, 16, v32
    v_and_b32 v50, 0xffff0000, v32
    v_lshlrev_b32 v49, 16, v33
    v_and_b32 v48, 0xffff0000, v33
    v_pk_fma_f32 v[208:209], v[48:49], v[24:25], v[208:209] op_sel_hi:[1,0,1]
    v_pk_fma_f32 v[210:211], v[50:51], v[24:25], v[210:211] op_sel_hi:[1,0,1]
    v_lshlrev_b32 v55, 16, v34
    v_and_b32 v54, 0xffff0000, v34
    v_lshlrev_b32 v53, 16, v35
    v_and_b32 v52, 0xffff0000, v35
    v_pk_fma_f32 v[212:213], v[52:53], v[24:25], v[212:213] op_sel_hi:[1,0,1]
    v_pk_fma_f32 v[214:215], v[54:55], v[24:25], v[214:215] op_sel_hi:[1,0,1]
    s_waitcnt lgkmcnt(2)
    v_pk_add_f32 v[64:65], v[64:65], v[72:73]
    v_pk_add_f32 v[66:67], v[66:67], v[74:75]
    v_pk_add_f32 v[68:69], v[68:69], v[76:77]
    v_pk_add_f32 v[70:71], v[70:71], v[78:79]
    v_pk_add_f32 v[208:209], v[208:209], v[64:65]
    v_pk_add_f32 v[210:211], v[210:211], v[66:67]
    v_pk_add_f32 v[212:213], v[212:213], v[68:69]
    v_pk_add_f32 v[214:215], v[214:215], v[70:71]
    s_waitcnt lgkmcnt(0)
    v_pk_add_f32 v[208:209], v[208:209], v[80:81]
    v_pk_add_f32 v[210:211], v[210:211], v[82:83]
    v_pk_add_f32 v[212:213], v[212:213], v[84:85]
    v_pk_add_f32 v[214:215], v[214:215], v[86:87]
    v_cvt_pk_bf16_f32 v56, v208, v209
    v_cvt_pk_bf16_f32 v57, v210, v211
    ds_write_b64 v26, v[56:57] offset:0
    v_cvt_pk_bf16_f32 v58, v212, v213
    v_cvt_pk_bf16_f32 v59, v214, v215
    ds_write_b64 v26, v[58:59] offset:1024
    s_branch adaLN_cond__ssm_conv_h3__mixer_s_mlp__prompt_kernel_cvend39
adaLN_cond__ssm_conv_h3__mixer_s_mlp__prompt_kernel_cv1_36:
    ds_write_b128 v4, v[224:227] offset:0
    ds_write_b128 v4, v[228:231] offset:1024
    ds_write_b128 v4, v[232:235] offset:2048
    ds_write_b128 v4, v[236:239] offset:3072
    ds_write_b128 v4, v[208:211] offset:4096
    ds_write_b128 v4, v[212:215] offset:5120
    ds_read_b64 v[32:33], v6 offset:2560
    ds_read_b64 v[34:35], v6 offset:2048
    s_waitcnt lgkmcnt(0)
    s_barrier
    ds_read_b128 v[64:67], v5 offset:0
    ds_read_b128 v[68:71], v5 offset:1024
    ds_read_b128 v[72:75], v5 offset:20480
    ds_read_b128 v[76:79], v5 offset:21504
    ds_read_b128 v[80:83], v5 offset:16384
    ds_read_b128 v[84:87], v5 offset:17408
    v_lshlrev_b32 v51, 16, v32
    v_and_b32 v50, 0xffff0000, v32
    v_lshlrev_b32 v49, 16, v33
    v_and_b32 v48, 0xffff0000, v33
    v_pk_fma_f32 v[216:217], v[48:49], v[24:25], v[216:217] op_sel_hi:[1,0,1]
    v_pk_fma_f32 v[218:219], v[50:51], v[24:25], v[218:219] op_sel_hi:[1,0,1]
    v_lshlrev_b32 v55, 16, v34
    v_and_b32 v54, 0xffff0000, v34
    v_lshlrev_b32 v53, 16, v35
    v_and_b32 v52, 0xffff0000, v35
    v_pk_fma_f32 v[220:221], v[52:53], v[24:25], v[220:221] op_sel_hi:[1,0,1]
    v_pk_fma_f32 v[222:223], v[54:55], v[24:25], v[222:223] op_sel_hi:[1,0,1]
    s_waitcnt lgkmcnt(2)
    v_pk_add_f32 v[64:65], v[64:65], v[72:73]
    v_pk_add_f32 v[66:67], v[66:67], v[74:75]
    v_pk_add_f32 v[68:69], v[68:69], v[76:77]
    v_pk_add_f32 v[70:71], v[70:71], v[78:79]
    v_pk_add_f32 v[216:217], v[216:217], v[64:65]
    v_pk_add_f32 v[218:219], v[218:219], v[66:67]
    v_pk_add_f32 v[220:221], v[220:221], v[68:69]
    v_pk_add_f32 v[222:223], v[222:223], v[70:71]
    s_waitcnt lgkmcnt(0)
    v_pk_add_f32 v[216:217], v[216:217], v[80:81]
    v_pk_add_f32 v[218:219], v[218:219], v[82:83]
    v_pk_add_f32 v[220:221], v[220:221], v[84:85]
    v_pk_add_f32 v[222:223], v[222:223], v[86:87]
    v_cvt_pk_bf16_f32 v56, v216, v217
    v_cvt_pk_bf16_f32 v57, v218, v219
    ds_write_b64 v26, v[56:57] offset:2048
    v_cvt_pk_bf16_f32 v58, v220, v221
    v_cvt_pk_bf16_f32 v59, v222, v223
    ds_write_b64 v26, v[58:59] offset:3072
    s_branch adaLN_cond__ssm_conv_h3__mixer_s_mlp__prompt_kernel_cvend39
adaLN_cond__ssm_conv_h3__mixer_s_mlp__prompt_kernel_cv2_37:
    ds_write_b128 v4, v[232:235] offset:0
    ds_write_b128 v4, v[236:239] offset:1024
    ds_write_b128 v4, v[208:211] offset:2048
    ds_write_b128 v4, v[212:215] offset:3072
    ds_write_b128 v4, v[216:219] offset:4096
    ds_write_b128 v4, v[220:223] offset:5120
    ds_read_b64 v[32:33], v6 offset:1536
    ds_read_b64 v[34:35], v6 offset:1024
    s_waitcnt lgkmcnt(0)
    s_barrier
    ds_read_b128 v[64:67], v5 offset:6144
    ds_read_b128 v[68:71], v5 offset:7168
    ds_read_b128 v[72:75], v5 offset:2048
    ds_read_b128 v[76:79], v5 offset:3072
    ds_read_b128 v[80:83], v5 offset:22528
    ds_read_b128 v[84:87], v5 offset:23552
    v_lshlrev_b32 v51, 16, v32
    v_and_b32 v50, 0xffff0000, v32
    v_lshlrev_b32 v49, 16, v33
    v_and_b32 v48, 0xffff0000, v33
    v_pk_fma_f32 v[224:225], v[48:49], v[24:25], v[224:225] op_sel_hi:[1,0,1]
    v_pk_fma_f32 v[226:227], v[50:51], v[24:25], v[226:227] op_sel_hi:[1,0,1]
    v_lshlrev_b32 v55, 16, v34
    v_and_b32 v54, 0xffff0000, v34
    v_lshlrev_b32 v53, 16, v35
    v_and_b32 v52, 0xffff0000, v35
    v_pk_fma_f32 v[228:229], v[52:53], v[24:25], v[228:229] op_sel_hi:[1,0,1]
    v_pk_fma_f32 v[230:231], v[54:55], v[24:25], v[230:231] op_sel_hi:[1,0,1]
    s_waitcnt lgkmcnt(2)
    v_pk_add_f32 v[64:65], v[64:65], v[72:73]
    v_pk_add_f32 v[66:67], v[66:67], v[74:75]
    v_pk_add_f32 v[68:69], v[68:69], v[76:77]
    v_pk_add_f32 v[70:71], v[70:71], v[78:79]
    v_pk_add_f32 v[224:225], v[224:225], v[64:65]
    v_pk_add_f32 v[226:227], v[226:227], v[66:67]
    v_pk_add_f32 v[228:229], v[228:229], v[68:69]
    v_pk_add_f32 v[230:231], v[230:231], v[70:71]
    s_waitcnt lgkmcnt(0)
    v_pk_add_f32 v[224:225], v[224:225], v[80:81]
    v_pk_add_f32 v[226:227], v[226:227], v[82:83]
    v_pk_add_f32 v[228:229], v[228:229], v[84:85]
    v_pk_add_f32 v[230:231], v[230:231], v[86:87]
    v_cvt_pk_bf16_f32 v56, v224, v225
    v_cvt_pk_bf16_f32 v57, v226, v227
    ds_write_b64 v26, v[56:57] offset:4096
    v_cvt_pk_bf16_f32 v58, v228, v229
    v_cvt_pk_bf16_f32 v59, v230, v231
    ds_write_b64 v26, v[58:59] offset:5120
    s_branch adaLN_cond__ssm_conv_h3__mixer_s_mlp__prompt_kernel_cvend39
adaLN_cond__ssm_conv_h3__mixer_s_mlp__prompt_kernel_cv3_38:
    ds_write_b128 v4, v[208:211] offset:0
    ds_write_b128 v4, v[212:215] offset:1024
    ds_write_b128 v4, v[216:219] offset:2048
    ds_write_b128 v4, v[220:223] offset:3072
    ds_write_b128 v4, v[224:227] offset:4096
    ds_write_b128 v4, v[228:231] offset:5120
    ds_read_b64 v[32:33], v6 offset:512
    ds_read_b64 v[34:35], v6 offset:0
    s_waitcnt lgkmcnt(0)
    s_barrier
    ds_read_b128 v[64:67], v5 offset:12288
    ds_read_b128 v[68:71], v5 offset:13312
    ds_read_b128 v[72:75], v5 offset:8192
    ds_read_b128 v[76:79], v5 offset:9216
    ds_read_b128 v[80:83], v5 offset:4096
    ds_read_b128 v[84:87], v5 offset:5120
    v_lshlrev_b32 v51, 16, v32
    v_and_b32 v50, 0xffff0000, v32
    v_lshlrev_b32 v49, 16, v33
    v_and_b32 v48, 0xffff0000, v33
    v_pk_fma_f32 v[232:233], v[48:49], v[24:25], v[232:233] op_sel_hi:[1,0,1]
    v_pk_fma_f32 v[234:235], v[50:51], v[24:25], v[234:235] op_sel_hi:[1,0,1]
    v_lshlrev_b32 v55, 16, v34
    v_and_b32 v54, 0xffff0000, v34
    v_lshlrev_b32 v53, 16, v35
    v_and_b32 v52, 0xffff0000, v35
    v_pk_fma_f32 v[236:237], v[52:53], v[24:25], v[236:237] op_sel_hi:[1,0,1]
    v_pk_fma_f32 v[238:239], v[54:55], v[24:25], v[238:239] op_sel_hi:[1,0,1]
    s_waitcnt lgkmcnt(2)
    v_pk_add_f32 v[64:65], v[64:65], v[72:73]
    v_pk_add_f32 v[66:67], v[66:67], v[74:75]
    v_pk_add_f32 v[68:69], v[68:69], v[76:77]
    v_pk_add_f32 v[70:71], v[70:71], v[78:79]
    v_pk_add_f32 v[232:233], v[232:233], v[64:65]
    v_pk_add_f32 v[234:235], v[234:235], v[66:67]
    v_pk_add_f32 v[236:237], v[236:237], v[68:69]
    v_pk_add_f32 v[238:239], v[238:239], v[70:71]
    s_waitcnt lgkmcnt(0)
    v_pk_add_f32 v[232:233], v[232:233], v[80:81]
    v_pk_add_f32 v[234:235], v[234:235], v[82:83]
    v_pk_add_f32 v[236:237], v[236:237], v[84:85]
    v_pk_add_f32 v[238:239], v[238:239], v[86:87]
    v_cvt_pk_bf16_f32 v56, v232, v233
    v_cvt_pk_bf16_f32 v57, v234, v235
    ds_write_b64 v26, v[56:57] offset:6144
    v_cvt_pk_bf16_f32 v58, v236, v237
    v_cvt_pk_bf16_f32 v59, v238, v239
    ds_write_b64 v26, v[58:59] offset:7168
adaLN_cond__ssm_conv_h3__mixer_s_mlp__prompt_kernel_cvend39:
    v_lshlrev_b32 v30, 4, v0
    s_waitcnt lgkmcnt(0)
    s_barrier
    ds_read_b128 v[32:35], v30 offset:0
    s_waitcnt lgkmcnt(0)
    v_min_u32 v32, 0xfffffffe, v32
    buffer_store_dwordx4 v[32:35], v162, s[28:31], s24 offen sc1
    s_mov_b32 s33, s49
    s_cmp_ge_u32 s5, 12
    s_cbranch_scc1 adaLN_cond__ssm_conv_h3__mixer_s_mlp__prompt_kernel_mend40
    s_waitcnt vmcnt(1)
    ds_read_b32 v64, v165 offset:0
    ds_read_b32 v66, v165 offset:512
    ds_read_b32 v68, v165 offset:1024
    ds_read_b32 v70, v165 offset:1536
    v_and_b32 v8, 3, v1
    v_lshlrev_b32 v8, 5, v8
    v_lshrrev_b32 v9, 4, v1
    v_lshl_add_u32 v8, v9, 3, v8
    s_lshl_b32 s3, s6, 7
    s_add_u32 s3, s3, 124928
    v_add_u32 v8, s3, v8
    s_waitcnt lgkmcnt(0)
    v_lshlrev_b32 v88, 16, v176
    v_and_b32 v89, 0xffff0000, v176
    v_lshlrev_b32 v90, 16, v177
    v_and_b32 v91, 0xffff0000, v177
    v_lshlrev_b32 v92, 16, v178
    v_and_b32 v93, 0xffff0000, v178
    v_lshlrev_b32 v94, 16, v179
    v_and_b32 v95, 0xffff0000, v179
    v_pk_mul_f32 v[80:81], v[88:89], v[64:65] op_sel_hi:[1,0]
    v_pk_mul_f32 v[82:83], v[90:91], v[64:65] op_sel_hi:[1,0]
    v_pk_mul_f32 v[84:85], v[92:93], v[64:65] op_sel_hi:[1,0]
    v_pk_mul_f32 v[86:87], v[94:95], v[64:65] op_sel_hi:[1,0]
    v_lshlrev_b32 v88, 16, v180
    v_and_b32 v89, 0xffff0000, v180
    v_lshlrev_b32 v90, 16, v181
    v_and_b32 v91, 0xffff0000, v181
    v_lshlrev_b32 v92, 16, v182
    v_and_b32 v93, 0xffff0000, v182
    v_lshlrev_b32 v94, 16, v183
    v_and_b32 v95, 0xffff0000, v183
    v_pk_fma_f32 v[80:81], v[88:89], v[66:67], v[80:81] op_sel_hi:[1,0,1]
    v_pk_fma_f32 v[82:83], v[90:91], v[66:67], v[82:83] op_sel_hi:[1,0,1]
    v_pk_fma_f32 v[84:85], v[92:93], v[66:67], v[84:85] op_sel_hi:[1,0,1]
    v_pk_fma_f32 v[86:87], v[94:95], v[66:67], v[86:87] op_sel_hi:[1,0,1]
    v_lshlrev_b32 v88, 16, v184
    v_and_b32 v89, 0xffff0000, v184
    v_lshlrev_b32 v90, 16, v185
    v_and_b32 v91, 0xffff0000, v185
    v_lshlrev_b32 v92, 16, v186
    v_and_b32 v93, 0xffff0000, v186
    v_lshlrev_b32 v94, 16, v187
    v_and_b32 v95, 0xffff0000, v187
    v_pk_fma_f32 v[80:81], v[88:89], v[68:69], v[80:81] op_sel_hi:[1,0,1]
    v_pk_fma_f32 v[82:83], v[90:91], v[68:69], v[82:83] op_sel_hi:[1,0,1]
    v_pk_fma_f32 v[84:85], v[92:93], v[68:69], v[84:85] op_sel_hi:[1,0,1]
    v_pk_fma_f32 v[86:87], v[94:95], v[68:69], v[86:87] op_sel_hi:[1,0,1]
    v_lshlrev_b32 v88, 16, v188
    v_and_b32 v89, 0xffff0000, v188
    v_lshlrev_b32 v90, 16, v189
    v_and_b32 v91, 0xffff0000, v189
    v_lshlrev_b32 v92, 16, v190
    v_and_b32 v93, 0xffff0000, v190
    v_lshlrev_b32 v94, 16, v191
    v_and_b32 v95, 0xffff0000, v191
    v_pk_fma_f32 v[80:81], v[88:89], v[70:71], v[80:81] op_sel_hi:[1,0,1]
    v_pk_fma_f32 v[82:83], v[90:91], v[70:71], v[82:83] op_sel_hi:[1,0,1]
    v_pk_fma_f32 v[84:85], v[92:93], v[70:71], v[84:85] op_sel_hi:[1,0,1]
    v_pk_fma_f32 v[86:87], v[94:95], v[70:71], v[86:87] op_sel_hi:[1,0,1]
    s_nop 0
    v_permlane32_swap_b32 v80, v84
    v_permlane32_swap_b32 v81, v85
    v_permlane32_swap_b32 v82, v86
    v_permlane32_swap_b32 v83, v87
    v_add_f32 v80, v80, v84
    v_add_f32 v81, v81, v85
    v_add_f32 v82, v82, v86
    v_add_f32 v83, v83, v87
    s_nop 0
    v_permlane16_swap_b32 v80, v82
    v_permlane16_swap_b32 v81, v83
    v_add_f32 v80, v80, v82
    v_add_f32 v81, v81, v83
    s_nop 0
    v_add_f32_dpp v80, v80, v80 row_ror:8 row_mask:0xf bank_mask:0xf
    v_add_f32_dpp v81, v81, v81 row_ror:8 row_mask:0xf bank_mask:0xf
    s_nop 0
    v_add_f32_dpp v80, v80, v80 row_ror:4 row_mask:0xf bank_mask:0xf
    v_add_f32_dpp v81, v81, v81 row_ror:4 row_mask:0xf bank_mask:0xf
    ds_write_b64 v8, v[80:81]
adaLN_cond__ssm_conv_h3__mixer_s_mlp__prompt_kernel_mend40:
    s_cmp_lg_u32 s6, 3
    s_cbranch_scc1 adaLN_cond__ssm_conv_h3__mixer_s_mlp__prompt_kernel_ow45
    v_min_u32 v252, 7, v1
    v_lshlrev_b32 v252, 7, v252
    s_mov_b32 s3, 4489216
    s_mov_b32 s45, 0
adaLN_cond__ssm_conv_h3__mixer_s_mlp__prompt_kernel_gp43:
    buffer_load_dwordx2 v[250:251], v252, s[28:31], s3 offen sc1
    s_waitcnt vmcnt(0)
    v_cmp_ne_u64 vcc, v[248:249], v[250:251]
    s_cbranch_vccz adaLN_cond__ssm_conv_h3__mixer_s_mlp__prompt_kernel_gp43y
    s_add_u32 s45, s45, 1
    s_cmp_lt_u32 s45, 2000000
    s_cbranch_scc1 adaLN_cond__ssm_conv_h3__mixer_s_mlp__prompt_kernel_gp43
adaLN_cond__ssm_conv_h3__mixer_s_mlp__prompt_kernel_gp43y:
adaLN_cond__ssm_conv_h3__mixer_s_mlp__prompt_kernel_ow45:
    s_waitcnt vmcnt(1) lgkmcnt(0)
    s_barrier
    s_cmp_lg_u32 s6, 3
    s_cbranch_scc1 adaLN_cond__ssm_conv_h3__mixer_s_mlp__prompt_kernel_ow46
    s_cmp_ge_u32 s5, 12
    s_cbranch_scc1 adaLN_cond__ssm_conv_h3__mixer_s_mlp__prompt_kernel_mend47
    v_and_b32 v8, 31, v1
    v_lshlrev_b32 v8, 2, v8
    v_add_u32 v9, 124928, v8
    ds_read_b32 v64, v9 offset:0
    ds_read_b32 v65, v9 offset:128
    ds_read_b32 v66, v9 offset:256
    ds_read_b32 v67, v9 offset:384
    ds_read_b32 v68, v9 offset:512
    ds_read_b32 v69, v9 offset:640
    ds_read_b32 v70, v9 offset:768
    ds_read_b32 v71, v9 offset:896
    s_lshr_b32 s3, s33, 4
    s_cmp_eq_u32 s3, 1
    s_cselect_b32 s7, 1.0, 0
    s_cmp_eq_u32 s3, 4
    s_cselect_b32 s7, 1.0, s7
    s_lshl_b32 s3, s33, 7
    s_add_u32 s3, s3, 5177344
    s_waitcnt lgkmcnt(0)
    v_add_f32 v64, v64, v65
    v_add_f32 v66, v66, v67
    v_add_f32 v68, v68, v69
    v_add_f32 v70, v70, v71
    v_add_f32 v64, v64, v66
    v_add_f32 v68, v68, v70
    v_add_f32 v64, v64, v68
    v_cvt_pk_bf16_f32 v64, v64, v64
    v_lshlrev_b32 v64, 16, v64
    v_add_f32 v64, s7, v64
    v_cvt_pk_bf16_f32 v64, v64, v64
    v_lshlrev_b32 v64, 16, v64
    buffer_store_dword v64, v8, s[28:31], s3 offen sc1
adaLN_cond__ssm_conv_h3__mixer_s_mlp__prompt_kernel_mend47:
adaLN_cond__ssm_conv_h3__mixer_s_mlp__prompt_kernel_ow46:
    s_cmp_ge_u32 s6, 3
    s_cbranch_scc1 adaLN_cond__ssm_conv_h3__mixer_s_mlp__prompt_kernel_qd48
    s_add_u32 s3, s5, 1
    s_and_b32 s3, s3, 30
    s_lshr_b32 s7, s6, 1
    s_mul_i32 s3, s3, s7
    s_cmp_lg_u32 s3, 0
    s_cbranch_scc1 adaLN_cond__ssm_conv_h3__mixer_s_mlp__prompt_kernel_qd48
    s_cmp_eq_u32 s5, 0
    s_cselect_b32 s3, -4, 8
    s_lshl_b32 s7, s6, 2
    s_cmp_eq_u32 s6, 2
    s_cselect_b32 s3, s3, s7
    s_sub_u32 s7, s39, s6
    s_add_u32 s3, s3, s7
    s_lshl_b32 s3, s3, 10
    s_lshl_b32 s7, s6, 12
    v_lshlrev_b32 v9, 4, v1
    v_xor_b32 v8, 0, v9
    v_add_u32 v8, s3, v8
    s_add_u32 m0, s7, 149504
    s_add_u32 s3, s3, 1024
    buffer_load_dwordx4 v8, s[8:11], 0 offen nt lds
    v_xor_b32 v8, 64, v9
    v_add_u32 v8, s3, v8
    s_add_u32 m0, s7, 150528
    s_add_u32 s3, s3, 1024
    buffer_load_dwordx4 v8, s[8:11], 0 offen nt lds
    v_xor_b32 v8, 128, v9
    v_add_u32 v8, s3, v8
    s_add_u32 m0, s7, 151552
    s_add_u32 s3, s3, 1024
    buffer_load_dwordx4 v8, s[8:11], 0 offen nt lds
    v_xor_b32 v8, 192, v9
    v_add_u32 v8, s3, v8
    s_add_u32 m0, s7, 152576
    s_add_u32 s3, s3, 1024
    buffer_load_dwordx4 v8, s[8:11], 0 offen nt lds
adaLN_cond__ssm_conv_h3__mixer_s_mlp__prompt_kernel_qd48:
    s_lshr_b32 s25, s6, 2
    s_and_b32 s26, s6, 3
    v_lshlrev_b32 v232, 4, v1
    s_lshl_b32 s48, s4, 5
    s_add_u32 s48, s48, s5
    s_lshr_b32 s3, s48, 2
    s_lshl_b32 s3, s3, 15
    s_and_b32 s7, s48, 3
    s_lshl_b32 s7, s7, 4
    s_add_u32 s3, s3, s7
    s_lshl_b32 s7, s6, 12
    s_add_u32 s3, s3, s7
    v_lshl_add_u32 v228, v1, 6, s3
    s_cmp_eq_u32 s5, 0
    s_cselect_b32 s49, 1, 0
    s_cselect_b32 s3, -1, 1
    s_mul_i32 s3, s3, 32720
    v_add_u32 v229, s3, v228
    v_and_b32 v4, 3, v1
    v_lshrrev_b32 v5, 2, v1
    s_add_u32 s3, s5, 1
    s_and_b32 s24, s3, 30
    s_add_u32 s8, s94, 2097152
    s_addc_u32 s9, s95, 0
    s_mov_b32 s10, 2097152
    s_mov_b32 s11, 0x20000
    s_mov_b32 s16, s78
    s_mov_b32 s17, s79
    s_mov_b32 s18, 524288
    s_mov_b32 s19, 0x20000
    s_mov_b32 s12, s80
    s_mov_b32 s13, s81
    s_mov_b32 s14, 524288
    s_mov_b32 s15, 0x20000
    v_lshrrev_b32 v8, 3, v1
    v_mul_u32_u24 v233, 1024, v8
    v_lshrrev_b32 v8, 4, v1
    v_lshlrev_b32 v8, 1, v8
    v_xor_b32 v8, v8, v1
    v_and_b32 v8, 7, v8
    v_lshl_add_u32 v233, v8, 4, v233
    s_lshr_b32 s3, s5, 3
    s_lshl_b32 s54, s4, 2
    s_add_u32 s54, s54, s3
    s_and_b32 s55, s5, 7
    s_lshl_b32 s36, s6, 13
    s_lshl_b32 s3, s55, 7
    s_add_u32 s36, s36, s3
    s_lshr_b32 s3, s5, 4
    s_lshl_b32 s56, s4, 1
    s_add_u32 s56, s56, s3
    s_and_b32 s57, s5, 15
    s_lshl_b32 s27, s54, 2
    s_add_u32 s27, s27, s26
    s_mul_i32 s37, s6, 28672
    s_lshl_b32 s3, s57, 8
    s_add_u32 s37, s37, s3
    s_and_b32 s39, s6, 1
    s_lshl_b32 s3, s25, 1
    s_add_u32 s39, s39, s3
    s_mul_i32 s38, s39, 458752
    s_bfe_u32 s3, s6, 0x10001
    s_lshl_b32 s3, s3, 14
    s_add_u32 s38, s38, s3
    s_lshl_b32 s3, s55, 7
    s_add_u32 s38, s38, s3
    v_and_b32 v8, 48, v1
    v_lshlrev_b32 v8, 1, v8
    v_lshl_add_u32 v8, v4, 3, v8
    v_bfe_u32 v9, v1, 2, 2
    v_add_u32 v8, v8, v9
    v_lshlrev_b32 v8, 4, v8
    s_lshl_b32 s3, s6, 3
    s_add_u32 s3, s3, 133120
    s_lshl_b32 s7, s49, 3
    s_add_u32 s7, s7, 141312
    s_cmp_eq_u32 s6, 2
    s_cselect_b32 s3, s7, s3
    v_add_u32 v44, s3, v8
    v_lshlrev_b32 v9, 2, v4
    v_xor_b32 v8, v5, v9
    v_lshlrev_b32 v8, 4, v8
    v_lshl_add_u32 v8, v4, 10, v8
    s_lshl_b32 s3, s6, 12
    s_add_u32 s3, s3, 149504
    v_add_u32 v46, s3, v8
    v_lshlrev_b32 v48, 5, v5
    v_add_u32 v48, 122880, v48
    v_lshrrev_b32 v8, 2, v5
    v_lshlrev_b32 v8, 8, v8
    v_and_b32 v9, 1, v5
    v_lshl_add_u32 v8, v9, 7, v8
    v_lshl_add_u32 v8, v4, 4, v8
    v_bfe_u32 v9, v5, 1, 1
    v_lshl_add_u32 v8, v9, 3, v8
    s_lshl_b32 s3, s6, 12
    s_add_u32 s3, s3, 114688
    v_add_u32 v50, s3, v8
    s_lshl_b32 s3, s6, 6
    s_add_u32 s3, s3, 161792
    v_lshl_add_u32 v51, v4, 4, s3
    v_lshrrev_b32 v8, 3, v1
    v_lshlrev_b32 v8, 6, v8
    v_lshl_add_u32 v8, v4, 4, v8
    s_lshl_b32 s3, s6, 9
    s_add_u32 s3, s3, 114688
    v_add_u32 v55, s3, v8
    v_bfe_u32 v9, v1, 2, 1
    v_lshl_add_u32 v52, v9, 12, v55
    v_lshrrev_b32 v8, 3, v1
    v_and_b32 v9, 7, v1
    v_mul_u32_u24 v53, 4352, v8
    v_lshl_add_u32 v53, v9, 4, v53
    v_lshlrev_b32 v54, 8, v8
    v_lshl_add_u32 v54, v9, 4, v54
    s_mul_i32 s58, s4, 278528
    s_add_u32 s58, s58, 7340032
    s_mul_i32 s3, s6, 34816
    s_add_u32 s20, s58, s3
    s_lshl_b32 s3, s5, 7
    s_add_u32 s3, s3, 128
    s_add_u32 s21, s20, s3
    s_cmp_eq_u32 s5, 0
    s_cselect_b32 s3, 0, 4224
    s_add_u32 s20, s20, s3
    s_lshr_b32 s3, s48, 1
    s_lshl_b32 s3, s3, 14
    s_and_b32 s7, s48, 1
    s_lshl_b32 s7, s7, 7
    s_add_u32 s3, s3, s7
    s_lshl_b32 s7, s6, 11
    s_add_u32 s3, s3, s7
    s_add_u32 s59, s3, 9699328
    v_mov_b32 v236, 0xc0135761
    v_mov_b32 v237, 0xbdd2d3e8
    s_mov_b32 s52, 0xbdd2d3e8
    s_mov_b32 s53, 0xbdd2d3e8
    v_lshrrev_b32 v8, 3, v1
    v_mul_u32_u24 v234, 3584, v8
    v_lshrrev_b32 v8, 4, v1
    v_lshlrev_b32 v8, 1, v8
    v_xor_b32 v8, v8, v1
    v_and_b32 v8, 7, v8
    v_lshl_add_u32 v234, v8, 4, v234
    v_lshrrev_b32 v8, 2, v1
    v_lshlrev_b32 v235, 7, v8
    v_and_b32 v8, 6, v8
    v_bfe_u32 v9, v1, 1, 1
    v_add_u32 v8, v8, v9
    v_lshl_add_u32 v235, v8, 4, v235
    v_and_b32 v9, 1, v1
    v_lshl_add_u32 v235, v9, 3, v235
    s_mov_b32 s60, s82
    s_mov_b32 s61, s83
    s_mov_b32 s62, 1835008
    s_mov_b32 s63, 0x20000
    s_cmp_ge_u32 s57, 14
    s_cselect_b32 s62, 0, s62
    s_lshl_b32 s3, s25, 6
    s_lshl_b32 s22, s25, 15
    s_xor_b32 s7, s3, 0
    v_xor_b32 v224, s7, v235
    v_add_u32 v224, s22, v224
    s_xor_b32 s7, s3, 32
    v_xor_b32 v225, s7, v235
    v_add_u32 v225, s22, v225
    s_xor_b32 s7, s3, 64
    v_xor_b32 v226, s7, v235
    v_add_u32 v226, s22, v226
    s_xor_b32 s7, s3, 96
    v_xor_b32 v227, s7, v235
    v_add_u32 v227, s22, v227
    s_cmp_lt_u32 s5, 12
    s_cselect_b32 s32, 1, 0
    s_cmp_ge_u32 s6, 3
    s_cbranch_scc1 adaLN_cond__ssm_conv_h3__mixer_s_mlp__prompt_kernel_gh41
    s_waitcnt vmcnt(0)
    ds_read_b128 v[8:11], v46 offset:0
    ds_read_b128 v[12:15], v46 offset:256
    ds_read_b128 v[16:19], v46 offset:512
    ds_read_b128 v[20:23], v46 offset:768
    s_waitcnt lgkmcnt(0)
    v_dot2_f32_bf16 v40, v8, s51, 0
    v_dot2_f32_bf16 v41, v8, v8, 0
    v_dot2_f32_bf16 v56, v9, s51, 0
    v_dot2_f32_bf16 v57, v9, v9, 0
    v_dot2_f32_bf16 v40, v10, s51, v40
    v_dot2_f32_bf16 v41, v10, v10, v41
    v_dot2_f32_bf16 v56, v11, s51, v56
    v_dot2_f32_bf16 v57, v11, v11, v57
    v_dot2_f32_bf16 v40, v12, s51, v40
    v_dot2_f32_bf16 v41, v12, v12, v41
    v_dot2_f32_bf16 v56, v13, s51, v56
    v_dot2_f32_bf16 v57, v13, v13, v57
    v_dot2_f32_bf16 v40, v14, s51, v40
    v_dot2_f32_bf16 v41, v14, v14, v41
    v_dot2_f32_bf16 v56, v15, s51, v56
    v_dot2_f32_bf16 v57, v15, v15, v57
    v_dot2_f32_bf16 v40, v16, s51, v40
    v_dot2_f32_bf16 v41, v16, v16, v41
    v_dot2_f32_bf16 v56, v17, s51, v56
    v_dot2_f32_bf16 v57, v17, v17, v57
    v_dot2_f32_bf16 v40, v18, s51, v40
    v_dot2_f32_bf16 v41, v18, v18, v41
    v_dot2_f32_bf16 v56, v19, s51, v56
    v_dot2_f32_bf16 v57, v19, v19, v57
    v_dot2_f32_bf16 v40, v20, s51, v40
    v_dot2_f32_bf16 v41, v20, v20, v41
    v_dot2_f32_bf16 v56, v21, s51, v56
    v_dot2_f32_bf16 v57, v21, v21, v57
    v_dot2_f32_bf16 v40, v22, s51, v40
    v_dot2_f32_bf16 v41, v22, v22, v41
    v_dot2_f32_bf16 v56, v23, s51, v56
    v_dot2_f32_bf16 v57, v23, v23, v57
    s_nop 2
    v_pk_add_f32 v[40:41], v[40:41], v[56:57]
    v_lshlrev_b32 v192, 16, v8
    v_and_b32 v193, 0xffff0000, v8
    v_lshlrev_b32 v194, 16, v9
    v_and_b32 v195, 0xffff0000, v9
    v_lshlrev_b32 v196, 16, v10
    v_and_b32 v197, 0xffff0000, v10
    v_lshlrev_b32 v198, 16, v11
    v_and_b32 v199, 0xffff0000, v11
    v_lshlrev_b32 v200, 16, v12
    v_and_b32 v201, 0xffff0000, v12
    v_lshlrev_b32 v202, 16, v13
    v_and_b32 v203, 0xffff0000, v13
    v_lshlrev_b32 v204, 16, v14
    v_and_b32 v205, 0xffff0000, v14
    v_lshlrev_b32 v206, 16, v15
    v_and_b32 v207, 0xffff0000, v15
    v_lshlrev_b32 v208, 16, v16
    v_and_b32 v209, 0xffff0000, v16
    v_lshlrev_b32 v210, 16, v17
    v_and_b32 v211, 0xffff0000, v17
    v_lshlrev_b32 v212, 16, v18
    v_and_b32 v213, 0xffff0000, v18
    v_lshlrev_b32 v214, 16, v19
    v_and_b32 v215, 0xffff0000, v19
    v_lshlrev_b32 v216, 16, v20
    v_and_b32 v217, 0xffff0000, v20
    v_lshlrev_b32 v218, 16, v21
    v_and_b32 v219, 0xffff0000, v21
    v_lshlrev_b32 v220, 16, v22
    v_and_b32 v221, 0xffff0000, v22
    v_lshlrev_b32 v222, 16, v23
    v_and_b32 v223, 0xffff0000, v23
    v_permlane32_swap_b32 v40, v41
    v_add_f32 v40, v40, v41
    v_mov_b32 v41, v40
    s_nop 1
    v_permlane16_swap_b32 v40, v41
    v_add_f32 v40, v40, v41
    s_nop 1
    v_add_f32_dpp v40, v40, v40 row_ror:4 row_mask:0xf bank_mask:0xf
    s_nop 1
    v_add_f32_dpp v40, v40, v40 row_ror:8 row_mask:0xf bank_mask:0xf
    v_mov_b32 v41, v40
    s_nop 1
    v_permlane32_swap_b32 v40, v41
    v_mul_f32 v40, 0x3b000000, v40
    v_mul_f32 v41, 0x3b000000, v41
    v_fma_f32 v41, -v40, v40, v41
    v_max_f32 v41, 0, v41
    v_add_f32 v41, 0x3727c5ac, v41
    v_rsq_f32 v42, v41
    s_nop 0
    v_mul_f32_e64 v43, -v40, v42
    v_pk_fma_f32 v[160:161], v[192:193], v[42:43], v[42:43] op_sel:[0,0,1] op_sel_hi:[1,0,1]
    v_pk_fma_f32 v[162:163], v[194:195], v[42:43], v[42:43] op_sel:[0,0,1] op_sel_hi:[1,0,1]
    v_pk_fma_f32 v[164:165], v[196:197], v[42:43], v[42:43] op_sel:[0,0,1] op_sel_hi:[1,0,1]
    v_pk_fma_f32 v[166:167], v[198:199], v[42:43], v[42:43] op_sel:[0,0,1] op_sel_hi:[1,0,1]
    v_pk_fma_f32 v[168:169], v[200:201], v[42:43], v[42:43] op_sel:[0,0,1] op_sel_hi:[1,0,1]
    v_pk_fma_f32 v[170:171], v[202:203], v[42:43], v[42:43] op_sel:[0,0,1] op_sel_hi:[1,0,1]
    v_pk_fma_f32 v[172:173], v[204:205], v[42:43], v[42:43] op_sel:[0,0,1] op_sel_hi:[1,0,1]
    v_pk_fma_f32 v[174:175], v[206:207], v[42:43], v[42:43] op_sel:[0,0,1] op_sel_hi:[1,0,1]
    v_pk_fma_f32 v[176:177], v[208:209], v[42:43], v[42:43] op_sel:[0,0,1] op_sel_hi:[1,0,1]
    v_pk_fma_f32 v[178:179], v[210:211], v[42:43], v[42:43] op_sel:[0,0,1] op_sel_hi:[1,0,1]
    v_pk_fma_f32 v[180:181], v[212:213], v[42:43], v[42:43] op_sel:[0,0,1] op_sel_hi:[1,0,1]
    v_pk_fma_f32 v[182:183], v[214:215], v[42:43], v[42:43] op_sel:[0,0,1] op_sel_hi:[1,0,1]
    v_pk_fma_f32 v[184:185], v[216:217], v[42:43], v[42:43] op_sel:[0,0,1] op_sel_hi:[1,0,1]
    v_pk_fma_f32 v[186:187], v[218:219], v[42:43], v[42:43] op_sel:[0,0,1] op_sel_hi:[1,0,1]
    v_pk_fma_f32 v[188:189], v[220:221], v[42:43], v[42:43] op_sel:[0,0,1] op_sel_hi:[1,0,1]
    v_pk_fma_f32 v[190:191], v[222:223], v[42:43], v[42:43] op_sel:[0,0,1] op_sel_hi:[1,0,1]
    s_branch adaLN_cond__ssm_conv_h3__mixer_s_mlp__prompt_kernel_gj42
adaLN_cond__ssm_conv_h3__mixer_s_mlp__prompt_kernel_gh41:
    s_cmp_eq_u32 s32, 1
    s_cbranch_scc1 adaLN_cond__ssm_conv_h3__mixer_s_mlp__prompt_kernel_gj42
    s_sub_u32 s3, s6, 3
    s_lshl_b32 s40, s3, 10
    s_lshl_b32 s41, s3, 13
    s_lshl_b32 s3, s55, 7
    s_add_u32 s41, s41, s3
    s_add_u32 m0, s40, 0
    s_add_u32 s7, s41, 0
    buffer_load_dwordx4 v233, s[16:19], s7 offen lds
    s_add_u32 m0, s40, 5120
    s_add_u32 s7, s41, 40960
    buffer_load_dwordx4 v233, s[16:19], s7 offen lds
    s_add_u32 m0, s40, 10240
    s_add_u32 s7, s41, 81920
    buffer_load_dwordx4 v233, s[16:19], s7 offen lds
    s_add_u32 m0, s40, 15360
    s_add_u32 s7, s41, 122880
    buffer_load_dwordx4 v233, s[16:19], s7 offen lds
    s_add_u32 m0, s40, 20480
    s_add_u32 s7, s41, 163840
    buffer_load_dwordx4 v233, s[16:19], s7 offen lds
    s_add_u32 m0, s40, 25600
    s_add_u32 s7, s41, 204800
    buffer_load_dwordx4 v233, s[16:19], s7 offen lds
    s_add_u32 m0, s40, 30720
    s_add_u32 s7, s41, 245760
    buffer_load_dwordx4 v233, s[16:19], s7 offen lds
    s_add_u32 m0, s40, 35840
    s_add_u32 s7, s41, 286720
    buffer_load_dwordx4 v233, s[16:19], s7 offen lds
    s_add_u32 m0, s40, 40960
    s_add_u32 s7, s41, 327680
    buffer_load_dwordx4 v233, s[16:19], s7 offen lds
    s_add_u32 m0, s40, 46080
    s_add_u32 s7, s41, 368640
    buffer_load_dwordx4 v233, s[16:19], s7 offen lds
    s_add_u32 m0, s40, 51200
    s_add_u32 s7, s41, 409600
    buffer_load_dwordx4 v233, s[16:19], s7 offen lds
    s_add_u32 m0, s40, 56320
    s_add_u32 s7, s41, 450560
    buffer_load_dwordx4 v233, s[16:19], s7 offen lds
    s_add_u32 m0, s40, 61440
    s_cmp_eq_u32 s6, 7
    s_cbranch_scc1 adaLN_cond__ssm_conv_h3__mixer_s_mlp__prompt_kernel_hx49
    s_add_u32 s7, s41, 491520
    buffer_load_dwordx4 v233, s[16:19], s7 offen lds
    s_branch adaLN_cond__ssm_conv_h3__mixer_s_mlp__prompt_kernel_hy50
adaLN_cond__ssm_conv_h3__mixer_s_mlp__prompt_kernel_hx49:
    s_lshl_b32 s7, s55, 7
    buffer_load_dwordx4 v233, s[12:15], s7 offen lds
adaLN_cond__ssm_conv_h3__mixer_s_mlp__prompt_kernel_hy50:
    s_add_u32 m0, s40, 66560
    s_add_u32 s7, s41, 8192
    buffer_load_dwordx4 v233, s[12:15], s7 offen lds
    s_add_u32 m0, s40, 71680
    s_add_u32 s7, s41, 49152
    buffer_load_dwordx4 v233, s[12:15], s7 offen lds
    s_add_u32 m0, s40, 76800
    s_add_u32 s7, s41, 90112
    buffer_load_dwordx4 v233, s[12:15], s7 offen lds
    s_add_u32 m0, s40, 81920
    s_add_u32 s7, s41, 131072
    buffer_load_dwordx4 v233, s[12:15], s7 offen lds
    s_add_u32 m0, s40, 87040
    s_add_u32 s7, s41, 172032
    buffer_load_dwordx4 v233, s[12:15], s7 offen lds
    s_add_u32 m0, s40, 92160
    s_add_u32 s7, s41, 212992
    buffer_load_dwordx4 v233, s[12:15], s7 offen lds
    s_add_u32 m0, s40, 97280
    s_add_u32 s7, s41, 253952
    buffer_load_dwordx4 v233, s[12:15], s7 offen lds
    s_add_u32 m0, s40, 102400
    s_add_u32 s7, s41, 294912
    buffer_load_dwordx4 v233, s[12:15], s7 offen lds
    s_add_u32 m0, s40, 107520
    s_add_u32 s7, s41, 335872
    buffer_load_dwordx4 v233, s[12:15], s7 offen lds
    s_cmp_ge_u32 s6, 5
    s_cbranch_scc1 adaLN_cond__ssm_conv_h3__mixer_s_mlp__prompt_kernel_hq51
    s_add_u32 m0, s40, 112640
    s_add_u32 s7, s41, 376832
    buffer_load_dwordx4 v233, s[12:15], s7 offen lds
adaLN_cond__ssm_conv_h3__mixer_s_mlp__prompt_kernel_hq51:
adaLN_cond__ssm_conv_h3__mixer_s_mlp__prompt_kernel_gj42:
    s_barrier
    s_cmp_lg_u32 s24, 0
    s_cselect_b32 s3, 2147483648, 0
    v_or_b32 v229, s3, v229
    s_cmp_lt_u32 s6, 4
    s_cselect_b32 s3, 2147483648, 0
    v_or_b32 v9, s3, v232
    s_add_u32 s40, s23, 5177344
    s_add_u32 s41, s40, 4096
    s_add_u32 s3, s23, 122880
    v_add_u32 v8, s3, v232
    s_mov_b32 s45, 0
    v_mov_b32 v72, 0
    v_mov_b32 v73, 0
    v_mov_b32 v74, 0
    v_mov_b32 v75, 0
    v_mov_b32 v76, 0
adaLN_cond__ssm_conv_h3__mixer_s_mlp__prompt_kernel_dp52:
    buffer_load_dwordx4 v[64:67], v228, s[8:11], 0 offen sc1
    buffer_load_dwordx4 v[68:71], v232, s[28:31], s40 offen sc1
    s_cmp_lt_u32 s6, 4
    s_cbranch_scc1 adaLN_cond__ssm_conv_h3__mixer_s_mlp__prompt_kernel_dp52a
    buffer_load_dwordx4 v[72:75], v9, s[28:31], s41 offen sc1
adaLN_cond__ssm_conv_h3__mixer_s_mlp__prompt_kernel_dp52a:
    s_cmp_lg_u32 s24, 0
    s_cbranch_scc1 adaLN_cond__ssm_conv_h3__mixer_s_mlp__prompt_kernel_dp52b
    buffer_load_dwordx4 v[76:79], v229, s[8:11], 0 offen sc1
adaLN_cond__ssm_conv_h3__mixer_s_mlp__prompt_kernel_dp52b:
    s_waitcnt vmcnt(0)
    v_max3_u32 v80, v64, v68, v69
    v_max3_u32 v81, v70, v71, v72
    v_max3_u32 v82, v73, v74, v75
    v_max3_u32 v80, v80, v81, v82
    v_max_u32 v80, v80, v76
    v_cmp_eq_u32 vcc, -1, v80
    s_add_u32 s45, s45, 1
    s_cmp_ge_u32 s45, 2000000
    s_cbranch_scc1 adaLN_cond__ssm_conv_h3__mixer_s_mlp__prompt_kernel_dd53
    s_and_b64 exec, exec, vcc
    s_cbranch_scc1 adaLN_cond__ssm_conv_h3__mixer_s_mlp__prompt_kernel_dp52
adaLN_cond__ssm_conv_h3__mixer_s_mlp__prompt_kernel_dd53:
    s_mov_b64 exec, -1
    ds_write_b128 v8, v[64:67] offset:10240
    ds_write_b128 v8, v[68:71]
    s_cmp_lg_u32 s24, 0
    s_cbranch_scc1 adaLN_cond__ssm_conv_h3__mixer_s_mlp__prompt_kernel_dd53h
    ds_write_b128 v8, v[76:79] offset:18432
adaLN_cond__ssm_conv_h3__mixer_s_mlp__prompt_kernel_dd53h:
    s_lshr_b32 s3, s6, 1
    s_cmp_lg_u32 s3, 2
    s_cbranch_scc1 adaLN_cond__ssm_conv_h3__mixer_s_mlp__prompt_kernel_dd53x
    ds_write_b128 v8, v[72:75] offset:4096
adaLN_cond__ssm_conv_h3__mixer_s_mlp__prompt_kernel_dd53x:
    s_waitcnt lgkmcnt(0)
    s_barrier
    s_cmp_ge_u32 s6, 3
    s_cbranch_scc1 adaLN_cond__ssm_conv_h3__mixer_s_mlp__prompt_kernel_help54
    s_lshr_b32 s3, s6, 1
    s_mul_i32 s3, s3, s24
    s_cmp_lg_u32 s3, 0
    s_cbranch_scc1 adaLN_cond__ssm_conv_h3__mixer_s_mlp__prompt_kernel_pj55
    s_mov_b32 s45, 0
    s_setprio 2
p_body:
    ds_read_b64_tr_b16 v[24:25], v44 offset:0
    ds_read_b64_tr_b16 v[26:27], v44 offset:64
    ds_read_b128 v[96:99], v48 offset:2048
    ds_read_b128 v[100:103], v48 offset:2064
    ds_read_b128 v[64:67], v48 offset:0
    ds_read_b128 v[68:71], v48 offset:16
    ds_read_b128 v[128:131], v48 offset:4096
    ds_read_b128 v[132:135], v48 offset:4112
    s_waitcnt lgkmcnt(7)
    ds_read_b64_tr_b16 v[28:29], v44 offset:2048
    ds_read_b64_tr_b16 v[30:31], v44 offset:2112
    ds_read_b128 v[104:107], v48 offset:2560
    ds_read_b128 v[108:111], v48 offset:2576
    ds_read_b128 v[72:75], v48 offset:512
    ds_read_b128 v[76:79], v48 offset:528
    ds_read_b128 v[136:139], v48 offset:4608
    ds_read_b128 v[140:143], v48 offset:4624
    s_waitcnt lgkmcnt(8)
    v_pk_fma_f32 v[160:161], v[160:161], v[96:97], v[64:65]
    v_pk_fma_f32 v[162:163], v[162:163], v[98:99], v[66:67]
    v_pk_fma_f32 v[164:165], v[164:165], v[100:101], v[68:69]
    v_pk_fma_f32 v[166:167], v[166:167], v[102:103], v[70:71]
    v_lshlrev_b32 v56, 16, v24
    v_and_b32 v57, 0xffff0000, v24
    v_lshlrev_b32 v58, 16, v25
    v_and_b32 v59, 0xffff0000, v25
    v_lshlrev_b32 v60, 16, v26
    v_and_b32 v61, 0xffff0000, v26
    v_lshlrev_b32 v62, 16, v27
    v_and_b32 v63, 0xffff0000, v27
    v_pk_mul_f32 v[56:57], v[56:57], v[128:129]
    v_pk_mul_f32 v[58:59], v[58:59], v[130:131]
    v_pk_mul_f32 v[60:61], v[60:61], v[132:133]
    v_pk_mul_f32 v[62:63], v[62:63], v[134:135]
    s_waitcnt lgkmcnt(7)
    ds_read_b64_tr_b16 v[32:33], v44 offset:4096
    ds_read_b64_tr_b16 v[34:35], v44 offset:4160
    ds_read_b128 v[112:115], v48 offset:3072
    ds_read_b128 v[116:119], v48 offset:3088
    ds_read_b128 v[80:83], v48 offset:1024
    ds_read_b128 v[84:87], v48 offset:1040
    ds_read_b128 v[144:147], v48 offset:5120
    ds_read_b128 v[148:151], v48 offset:5136
    v_pk_fma_f32 v[192:193], v[160:161], v[56:57], v[192:193]
    v_pk_fma_f32 v[194:195], v[162:163], v[58:59], v[194:195]
    v_pk_fma_f32 v[196:197], v[164:165], v[60:61], v[196:197]
    v_pk_fma_f32 v[198:199], v[166:167], v[62:63], v[198:199]
    v_cvt_pk_bf16_f32 v8, v192, v193
    v_cvt_pk_bf16_f32 v9, v194, v195
    v_cvt_pk_bf16_f32 v10, v196, v197
    v_cvt_pk_bf16_f32 v11, v198, v199
    s_waitcnt lgkmcnt(8)
    v_pk_fma_f32 v[168:169], v[168:169], v[104:105], v[72:73]
    v_pk_fma_f32 v[170:171], v[170:171], v[106:107], v[74:75]
    v_pk_fma_f32 v[172:173], v[172:173], v[108:109], v[76:77]
    v_pk_fma_f32 v[174:175], v[174:175], v[110:111], v[78:79]
    v_lshlrev_b32 v56, 16, v28
    v_and_b32 v57, 0xffff0000, v28
    v_lshlrev_b32 v58, 16, v29
    v_and_b32 v59, 0xffff0000, v29
    v_lshlrev_b32 v60, 16, v30
    v_and_b32 v61, 0xffff0000, v30
    v_lshlrev_b32 v62, 16, v31
    v_and_b32 v63, 0xffff0000, v31
    v_pk_mul_f32 v[56:57], v[56:57], v[136:137]
    v_pk_mul_f32 v[58:59], v[58:59], v[138:139]
    v_pk_mul_f32 v[60:61], v[60:61], v[140:141]
    v_pk_mul_f32 v[62:63], v[62:63], v[142:143]
    s_waitcnt lgkmcnt(7)
    ds_read_b64_tr_b16 v[36:37], v44 offset:6144
    ds_read_b64_tr_b16 v[38:39], v44 offset:6208
    ds_read_b128 v[120:123], v48 offset:3584
    ds_read_b128 v[124:127], v48 offset:3600
    ds_read_b128 v[88:91], v48 offset:1536
    ds_read_b128 v[92:95], v48 offset:1552
    ds_read_b128 v[152:155], v48 offset:5632
    ds_read_b128 v[156:159], v48 offset:5648
    v_pk_fma_f32 v[200:201], v[168:169], v[56:57], v[200:201]
    v_pk_fma_f32 v[202:203], v[170:171], v[58:59], v[202:203]
    v_pk_fma_f32 v[204:205], v[172:173], v[60:61], v[204:205]
    v_pk_fma_f32 v[206:207], v[174:175], v[62:63], v[206:207]
    v_cvt_pk_bf16_f32 v12, v200, v201
    v_cvt_pk_bf16_f32 v13, v202, v203
    v_cvt_pk_bf16_f32 v14, v204, v205
    v_cvt_pk_bf16_f32 v15, v206, v207
    s_waitcnt lgkmcnt(8)
    v_pk_fma_f32 v[176:177], v[176:177], v[112:113], v[80:81]
    v_pk_fma_f32 v[178:179], v[178:179], v[114:115], v[82:83]
    v_pk_fma_f32 v[180:181], v[180:181], v[116:117], v[84:85]
    v_pk_fma_f32 v[182:183], v[182:183], v[118:119], v[86:87]
    v_lshlrev_b32 v56, 16, v32
    v_and_b32 v57, 0xffff0000, v32
    v_lshlrev_b32 v58, 16, v33
    v_and_b32 v59, 0xffff0000, v33
    v_lshlrev_b32 v60, 16, v34
    v_and_b32 v61, 0xffff0000, v34
    v_lshlrev_b32 v62, 16, v35
    v_and_b32 v63, 0xffff0000, v35
    v_pk_mul_f32 v[56:57], v[56:57], v[144:145]
    v_pk_mul_f32 v[58:59], v[58:59], v[146:147]
    v_pk_mul_f32 v[60:61], v[60:61], v[148:149]
    v_pk_mul_f32 v[62:63], v[62:63], v[150:151]
    ds_read_b128 v[96:99], v48 offset:8192
    ds_read_b128 v[100:103], v48 offset:8208
    ds_read_b128 v[64:67], v48 offset:6144
    ds_read_b128 v[68:71], v48 offset:6160
    v_pk_fma_f32 v[208:209], v[176:177], v[56:57], v[208:209]
    v_pk_fma_f32 v[210:211], v[178:179], v[58:59], v[210:211]
    v_pk_fma_f32 v[212:213], v[180:181], v[60:61], v[212:213]
    v_pk_fma_f32 v[214:215], v[182:183], v[62:63], v[214:215]
    v_cvt_pk_bf16_f32 v16, v208, v209
    v_cvt_pk_bf16_f32 v17, v210, v211
    v_cvt_pk_bf16_f32 v18, v212, v213
    v_cvt_pk_bf16_f32 v19, v214, v215
    s_waitcnt lgkmcnt(4)
    v_pk_fma_f32 v[184:185], v[184:185], v[120:121], v[88:89]
    v_pk_fma_f32 v[186:187], v[186:187], v[122:123], v[90:91]
    v_pk_fma_f32 v[188:189], v[188:189], v[124:125], v[92:93]
    v_pk_fma_f32 v[190:191], v[190:191], v[126:127], v[94:95]
    v_lshlrev_b32 v56, 16, v36
    v_and_b32 v57, 0xffff0000, v36
    v_lshlrev_b32 v58, 16, v37
    v_and_b32 v59, 0xffff0000, v37
    v_lshlrev_b32 v60, 16, v38
    v_and_b32 v61, 0xffff0000, v38
    v_lshlrev_b32 v62, 16, v39
    v_and_b32 v63, 0xffff0000, v39
    v_pk_mul_f32 v[56:57], v[56:57], v[152:153]
    v_pk_mul_f32 v[58:59], v[58:59], v[154:155]
    v_pk_mul_f32 v[60:61], v[60:61], v[156:157]
    v_pk_mul_f32 v[62:63], v[62:63], v[158:159]
    ds_read_b128 v[104:107], v48 offset:8704
    ds_read_b128 v[108:111], v48 offset:8720
    ds_read_b128 v[72:75], v48 offset:6656
    ds_read_b128 v[76:79], v48 offset:6672
    ds_read_b128 v[112:115], v48 offset:9216
    ds_read_b128 v[116:119], v48 offset:9232
    ds_read_b128 v[80:83], v48 offset:7168
    ds_read_b128 v[84:87], v48 offset:7184
    v_pk_fma_f32 v[216:217], v[184:185], v[56:57], v[216:217]
    v_pk_fma_f32 v[218:219], v[186:187], v[58:59], v[218:219]
    v_pk_fma_f32 v[220:221], v[188:189], v[60:61], v[220:221]
    v_pk_fma_f32 v[222:223], v[190:191], v[62:63], v[222:223]
    v_cvt_pk_bf16_f32 v20, v216, v217
    v_cvt_pk_bf16_f32 v21, v218, v219
    v_cvt_pk_bf16_f32 v22, v220, v221
    v_cvt_pk_bf16_f32 v23, v222, v223
    s_waitcnt lgkmcnt(8)
    ds_read_b128 v[120:123], v48 offset:9728
    ds_read_b128 v[124:127], v48 offset:9744
    ds_read_b128 v[88:91], v48 offset:7680
    ds_read_b128 v[92:95], v48 offset:7696
    v_dot2_f32_bf16 v40, v8, s51, 0
    v_dot2_f32_bf16 v41, v8, v8, 0
    v_dot2_f32_bf16 v56, v9, s51, 0
    v_dot2_f32_bf16 v57, v9, v9, 0
    v_dot2_f32_bf16 v40, v10, s51, v40
    v_dot2_f32_bf16 v41, v10, v10, v41
    v_dot2_f32_bf16 v56, v11, s51, v56
    v_dot2_f32_bf16 v57, v11, v11, v57
    v_dot2_f32_bf16 v40, v12, s51, v40
    v_dot2_f32_bf16 v41, v12, v12, v41
    v_dot2_f32_bf16 v56, v13, s51, v56
    v_dot2_f32_bf16 v57, v13, v13, v57
    v_dot2_f32_bf16 v40, v14, s51, v40
    v_dot2_f32_bf16 v41, v14, v14, v41
    v_dot2_f32_bf16 v56, v15, s51, v56
    v_dot2_f32_bf16 v57, v15, v15, v57
    v_dot2_f32_bf16 v40, v16, s51, v40
    v_dot2_f32_bf16 v41, v16, v16, v41
    v_dot2_f32_bf16 v56, v17, s51, v56
    v_dot2_f32_bf16 v57, v17, v17, v57
    v_dot2_f32_bf16 v40, v18, s51, v40
    v_dot2_f32_bf16 v41, v18, v18, v41
    v_dot2_f32_bf16 v56, v19, s51, v56
    v_dot2_f32_bf16 v57, v19, v19, v57
    v_dot2_f32_bf16 v40, v20, s51, v40
    v_dot2_f32_bf16 v41, v20, v20, v41
    v_dot2_f32_bf16 v56, v21, s51, v56
    v_dot2_f32_bf16 v57, v21, v21, v57
    v_dot2_f32_bf16 v40, v22, s51, v40
    v_dot2_f32_bf16 v41, v22, v22, v41
    v_dot2_f32_bf16 v56, v23, s51, v56
    v_dot2_f32_bf16 v57, v23, v23, v57
    s_nop 2
    v_pk_add_f32 v[40:41], v[40:41], v[56:57]
    s_nop 1
    v_permlane32_swap_b32 v40, v41
    v_add_f32 v40, v40, v41
    v_mov_b32 v41, v40
    s_nop 1
    v_permlane16_swap_b32 v40, v41
    v_add_f32 v40, v40, v41
    s_nop 1
    v_add_f32_dpp v40, v40, v40 row_ror:4 row_mask:0xf bank_mask:0xf
    s_nop 1
    v_add_f32_dpp v40, v40, v40 row_ror:8 row_mask:0xf bank_mask:0xf
    v_mov_b32 v41, v40
    s_nop 1
    v_permlane32_swap_b32 v40, v41
    v_mul_f32 v40, 0x3b000000, v40
    v_mul_f32 v41, 0x3b000000, v41
    v_fma_f32 v41, -v40, v40, v41
    v_max_f32 v41, 0, v41
    v_add_f32 v41, 0x3727c5ac, v41
    v_rsq_f32 v42, v41
    s_nop 0
    v_mul_f32_e64 v43, -v40, v42
    s_waitcnt lgkmcnt(0)
    v_pk_fma_f32 v[192:193], v[192:193], v[42:43], v[42:43] op_sel:[0,0,1] op_sel_hi:[1,0,1]
    v_pk_fma_f32 v[194:195], v[194:195], v[42:43], v[42:43] op_sel:[0,0,1] op_sel_hi:[1,0,1]
    v_pk_fma_f32 v[196:197], v[196:197], v[42:43], v[42:43] op_sel:[0,0,1] op_sel_hi:[1,0,1]
    v_pk_fma_f32 v[198:199], v[198:199], v[42:43], v[42:43] op_sel:[0,0,1] op_sel_hi:[1,0,1]
    v_pk_fma_f32 v[200:201], v[200:201], v[42:43], v[42:43] op_sel:[0,0,1] op_sel_hi:[1,0,1]
    v_pk_fma_f32 v[202:203], v[202:203], v[42:43], v[42:43] op_sel:[0,0,1] op_sel_hi:[1,0,1]
    v_pk_fma_f32 v[204:205], v[204:205], v[42:43], v[42:43] op_sel:[0,0,1] op_sel_hi:[1,0,1]
    v_pk_fma_f32 v[206:207], v[206:207], v[42:43], v[42:43] op_sel:[0,0,1] op_sel_hi:[1,0,1]
    v_pk_fma_f32 v[208:209], v[208:209], v[42:43], v[42:43] op_sel:[0,0,1] op_sel_hi:[1,0,1]
    v_pk_fma_f32 v[210:211], v[210:211], v[42:43], v[42:43] op_sel:[0,0,1] op_sel_hi:[1,0,1]
    v_pk_fma_f32 v[212:213], v[212:213], v[42:43], v[42:43] op_sel:[0,0,1] op_sel_hi:[1,0,1]
    v_pk_fma_f32 v[214:215], v[214:215], v[42:43], v[42:43] op_sel:[0,0,1] op_sel_hi:[1,0,1]
    v_pk_fma_f32 v[216:217], v[216:217], v[42:43], v[42:43] op_sel:[0,0,1] op_sel_hi:[1,0,1]
    v_pk_fma_f32 v[218:219], v[218:219], v[42:43], v[42:43] op_sel:[0,0,1] op_sel_hi:[1,0,1]
    v_pk_fma_f32 v[220:221], v[220:221], v[42:43], v[42:43] op_sel:[0,0,1] op_sel_hi:[1,0,1]
    v_pk_fma_f32 v[222:223], v[222:223], v[42:43], v[42:43] op_sel:[0,0,1] op_sel_hi:[1,0,1]
    v_pk_fma_f32 v[192:193], v[192:193], v[96:97], v[64:65]
    v_pk_fma_f32 v[194:195], v[194:195], v[98:99], v[66:67]
    v_pk_fma_f32 v[196:197], v[196:197], v[100:101], v[68:69]
    v_pk_fma_f32 v[198:199], v[198:199], v[102:103], v[70:71]
    v_pk_fma_f32 v[200:201], v[200:201], v[104:105], v[72:73]
    v_pk_fma_f32 v[202:203], v[202:203], v[106:107], v[74:75]
    v_pk_fma_f32 v[204:205], v[204:205], v[108:109], v[76:77]
    v_pk_fma_f32 v[206:207], v[206:207], v[110:111], v[78:79]
    v_pk_fma_f32 v[208:209], v[208:209], v[112:113], v[80:81]
    v_pk_fma_f32 v[210:211], v[210:211], v[114:115], v[82:83]
    v_pk_fma_f32 v[212:213], v[212:213], v[116:117], v[84:85]
    v_pk_fma_f32 v[214:215], v[214:215], v[118:119], v[86:87]
    v_pk_fma_f32 v[216:217], v[216:217], v[120:121], v[88:89]
    v_pk_fma_f32 v[218:219], v[218:219], v[122:123], v[90:91]
    v_pk_fma_f32 v[220:221], v[220:221], v[124:125], v[92:93]
    v_pk_fma_f32 v[222:223], v[222:223], v[126:127], v[94:95]
    v_cvt_pk_bf16_f32 v24, v192, v193
    v_cvt_pk_bf16_f32 v25, v194, v195
    v_cvt_pk_bf16_f32 v26, v196, v197
    v_cvt_pk_bf16_f32 v27, v198, v199
    v_cvt_pk_bf16_f32 v28, v200, v201
    v_cvt_pk_bf16_f32 v29, v202, v203
    v_cvt_pk_bf16_f32 v30, v204, v205
    v_cvt_pk_bf16_f32 v31, v206, v207
    v_cvt_pk_bf16_f32 v32, v208, v209
    v_cvt_pk_bf16_f32 v33, v210, v211
    v_cvt_pk_bf16_f32 v34, v212, v213
    v_cvt_pk_bf16_f32 v35, v214, v215
    v_cvt_pk_bf16_f32 v36, v216, v217
    v_cvt_pk_bf16_f32 v37, v218, v219
    v_cvt_pk_bf16_f32 v38, v220, v221
    v_cvt_pk_bf16_f32 v39, v222, v223
    v_mov_b32 v60, v42
    v_mov_b32 v61, v43
    v_mov_b32 v62, v42
    v_mov_b32 v63, v43
    s_cmp_eq_u32 s6, 2
    s_cbranch_scc1 adaLN_cond__ssm_conv_h3__mixer_s_mlp__prompt_kernel_nx156
    ds_write_b64 v50, v[8:9] offset:0
    ds_write_b64 v50, v[10:11] offset:64
    ds_write_b64 v50, v[12:13] offset:1024
    ds_write_b64 v50, v[14:15] offset:1088
    ds_write_b64 v50, v[16:17] offset:2048
    ds_write_b64 v50, v[18:19] offset:2112
    ds_write_b64 v50, v[20:21] offset:3072
    ds_write_b64 v50, v[22:23] offset:3136
    ds_write_b128 v51, v[60:63]
adaLN_cond__ssm_conv_h3__mixer_s_mlp__prompt_kernel_nx156:
    v_dot2_f32_bf16 v40, v24, s51, 0
    v_dot2_f32_bf16 v41, v24, v24, 0
    v_dot2_f32_bf16 v56, v25, s51, 0
    v_dot2_f32_bf16 v57, v25, v25, 0
    v_dot2_f32_bf16 v40, v26, s51, v40
    v_dot2_f32_bf16 v41, v26, v26, v41
    v_dot2_f32_bf16 v56, v27, s51, v56
    v_dot2_f32_bf16 v57, v27, v27, v57
    v_dot2_f32_bf16 v40, v28, s51, v40
    v_dot2_f32_bf16 v41, v28, v28, v41
    v_dot2_f32_bf16 v56, v29, s51, v56
    v_dot2_f32_bf16 v57, v29, v29, v57
    v_dot2_f32_bf16 v40, v30, s51, v40
    v_dot2_f32_bf16 v41, v30, v30, v41
    v_dot2_f32_bf16 v56, v31, s51, v56
    v_dot2_f32_bf16 v57, v31, v31, v57
    v_dot2_f32_bf16 v40, v32, s51, v40
    v_dot2_f32_bf16 v41, v32, v32, v41
    v_dot2_f32_bf16 v56, v33, s51, v56
    v_dot2_f32_bf16 v57, v33, v33, v57
    v_dot2_f32_bf16 v40, v34, s51, v40
    v_dot2_f32_bf16 v41, v34, v34, v41
    v_dot2_f32_bf16 v56, v35, s51, v56
    v_dot2_f32_bf16 v57, v35, v35, v57
    v_dot2_f32_bf16 v40, v36, s51, v40
    v_dot2_f32_bf16 v41, v36, v36, v41
    v_dot2_f32_bf16 v56, v37, s51, v56
    v_dot2_f32_bf16 v57, v37, v37, v57
    v_dot2_f32_bf16 v40, v38, s51, v40
    v_dot2_f32_bf16 v41, v38, v38, v41
    v_dot2_f32_bf16 v56, v39, s51, v56
    v_dot2_f32_bf16 v57, v39, v39, v57
    s_nop 2
    v_pk_add_f32 v[40:41], v[40:41], v[56:57]
    s_nop 1
    v_permlane32_swap_b32 v40, v41
    v_add_f32 v40, v40, v41
    v_mov_b32 v41, v40
    s_nop 1
    v_permlane16_swap_b32 v40, v41
    v_add_f32 v40, v40, v41
    s_nop 1
    v_add_f32_dpp v40, v40, v40 row_ror:4 row_mask:0xf bank_mask:0xf
    s_nop 1
    v_add_f32_dpp v40, v40, v40 row_ror:8 row_mask:0xf bank_mask:0xf
    v_mov_b32 v41, v40
    s_nop 1
    v_permlane32_swap_b32 v40, v41
    v_mul_f32 v40, 0x3b000000, v40
    v_mul_f32 v41, 0x3b000000, v41
    v_fma_f32 v41, -v40, v40, v41
    v_max_f32 v41, 0, v41
    v_add_f32 v41, 0x3727c5ac, v41
    v_rsq_f32 v42, v41
    s_nop 0
    v_mul_f32_e64 v43, -v40, v42
    v_pk_fma_f32 v[192:193], v[192:193], v[42:43], v[42:43] op_sel:[0,0,1] op_sel_hi:[1,0,1]
    v_pk_fma_f32 v[194:195], v[194:195], v[42:43], v[42:43] op_sel:[0,0,1] op_sel_hi:[1,0,1]
    v_pk_fma_f32 v[196:197], v[196:197], v[42:43], v[42:43] op_sel:[0,0,1] op_sel_hi:[1,0,1]
    v_pk_fma_f32 v[198:199], v[198:199], v[42:43], v[42:43] op_sel:[0,0,1] op_sel_hi:[1,0,1]
    v_pk_fma_f32 v[200:201], v[200:201], v[42:43], v[42:43] op_sel:[0,0,1] op_sel_hi:[1,0,1]
    v_pk_fma_f32 v[202:203], v[202:203], v[42:43], v[42:43] op_sel:[0,0,1] op_sel_hi:[1,0,1]
    v_pk_fma_f32 v[204:205], v[204:205], v[42:43], v[42:43] op_sel:[0,0,1] op_sel_hi:[1,0,1]
    v_pk_fma_f32 v[206:207], v[206:207], v[42:43], v[42:43] op_sel:[0,0,1] op_sel_hi:[1,0,1]
    v_pk_fma_f32 v[208:209], v[208:209], v[42:43], v[42:43] op_sel:[0,0,1] op_sel_hi:[1,0,1]
    v_pk_fma_f32 v[210:211], v[210:211], v[42:43], v[42:43] op_sel:[0,0,1] op_sel_hi:[1,0,1]
    v_pk_fma_f32 v[212:213], v[212:213], v[42:43], v[42:43] op_sel:[0,0,1] op_sel_hi:[1,0,1]
    v_pk_fma_f32 v[214:215], v[214:215], v[42:43], v[42:43] op_sel:[0,0,1] op_sel_hi:[1,0,1]
    v_pk_fma_f32 v[216:217], v[216:217], v[42:43], v[42:43] op_sel:[0,0,1] op_sel_hi:[1,0,1]
    v_pk_fma_f32 v[218:219], v[218:219], v[42:43], v[42:43] op_sel:[0,0,1] op_sel_hi:[1,0,1]
    v_pk_fma_f32 v[220:221], v[220:221], v[42:43], v[42:43] op_sel:[0,0,1] op_sel_hi:[1,0,1]
    v_pk_fma_f32 v[222:223], v[222:223], v[42:43], v[42:43] op_sel:[0,0,1] op_sel_hi:[1,0,1]
    s_waitcnt lgkmcnt(4)
    v_cvt_pk_bf16_f32 v24, v192, v193
    v_cvt_pk_bf16_f32 v25, v194, v195
    ds_write_b64 v50, v[24:25] offset:34816
    v_cvt_pk_bf16_f32 v26, v196, v197
    v_cvt_pk_bf16_f32 v27, v198, v199
    ds_write_b64 v50, v[26:27] offset:34880
    v_cvt_pk_bf16_f32 v28, v200, v201
    v_cvt_pk_bf16_f32 v29, v202, v203
    ds_write_b64 v50, v[28:29] offset:35840
    v_cvt_pk_bf16_f32 v30, v204, v205
    v_cvt_pk_bf16_f32 v31, v206, v207
    ds_write_b64 v50, v[30:31] offset:35904
    v_cvt_pk_bf16_f32 v32, v208, v209
    v_cvt_pk_bf16_f32 v33, v210, v211
    ds_write_b64 v50, v[32:33] offset:36864
    v_cvt_pk_bf16_f32 v34, v212, v213
    v_cvt_pk_bf16_f32 v35, v214, v215
    ds_write_b64 v50, v[34:35] offset:36928
    v_cvt_pk_bf16_f32 v36, v216, v217
    v_cvt_pk_bf16_f32 v37, v218, v219
    ds_write_b64 v50, v[36:37] offset:37888
    v_cvt_pk_bf16_f32 v38, v220, v221
    v_cvt_pk_bf16_f32 v39, v222, v223
    ds_write_b64 v50, v[38:39] offset:37952
    s_setprio 0
    s_branch adaLN_cond__ssm_conv_h3__mixer_s_mlp__prompt_kernel_pj55
adaLN_cond__ssm_conv_h3__mixer_s_mlp__prompt_kernel_help54:
    s_cmp_lg_u32 s32, 1
    s_cbranch_scc1 adaLN_cond__ssm_conv_h3__mixer_s_mlp__prompt_kernel_hl57
    s_sub_u32 s3, s6, 3
    s_lshl_b32 s40, s3, 10
    s_lshl_b32 s41, s3, 13
    s_lshl_b32 s3, s55, 7
    s_add_u32 s41, s41, s3
    s_add_u32 m0, s40, 0
    s_add_u32 s7, s41, 0
    buffer_load_dwordx4 v233, s[16:19], s7 offen lds
    s_add_u32 m0, s40, 5120
    s_add_u32 s7, s41, 40960
    buffer_load_dwordx4 v233, s[16:19], s7 offen lds
    s_add_u32 m0, s40, 10240
    s_add_u32 s7, s41, 81920
    buffer_load_dwordx4 v233, s[16:19], s7 offen lds
    s_add_u32 m0, s40, 15360
    s_add_u32 s7, s41, 122880
    buffer_load_dwordx4 v233, s[16:19], s7 offen lds
    s_add_u32 m0, s40, 20480
    s_add_u32 s7, s41, 163840
    buffer_load_dwordx4 v233, s[16:19], s7 offen lds
    s_add_u32 m0, s40, 25600
    s_add_u32 s7, s41, 204800
    buffer_load_dwordx4 v233, s[16:19], s7 offen lds
    s_add_u32 m0, s40, 30720
    s_add_u32 s7, s41, 245760
    buffer_load_dwordx4 v233, s[16:19], s7 offen lds
    s_add_u32 m0, s40, 35840
    s_add_u32 s7, s41, 286720
    buffer_load_dwordx4 v233, s[16:19], s7 offen lds
    s_add_u32 m0, s40, 40960
    s_add_u32 s7, s41, 327680
    buffer_load_dwordx4 v233, s[16:19], s7 offen lds
    s_add_u32 m0, s40, 46080
    s_add_u32 s7, s41, 368640
    buffer_load_dwordx4 v233, s[16:19], s7 offen lds
    s_add_u32 m0, s40, 51200
    s_add_u32 s7, s41, 409600
    buffer_load_dwordx4 v233, s[16:19], s7 offen lds
    s_add_u32 m0, s40, 56320
    s_add_u32 s7, s41, 450560
    buffer_load_dwordx4 v233, s[16:19], s7 offen lds
    s_add_u32 m0, s40, 61440
    s_cmp_eq_u32 s6, 7
    s_cbranch_scc1 adaLN_cond__ssm_conv_h3__mixer_s_mlp__prompt_kernel_hx59
    s_add_u32 s7, s41, 491520
    buffer_load_dwordx4 v233, s[16:19], s7 offen lds
    s_branch adaLN_cond__ssm_conv_h3__mixer_s_mlp__prompt_kernel_hy60
adaLN_cond__ssm_conv_h3__mixer_s_mlp__prompt_kernel_hx59:
    s_lshl_b32 s7, s55, 7
    buffer_load_dwordx4 v233, s[12:15], s7 offen lds
adaLN_cond__ssm_conv_h3__mixer_s_mlp__prompt_kernel_hy60:
    s_add_u32 m0, s40, 66560
    s_add_u32 s7, s41, 8192
    buffer_load_dwordx4 v233, s[12:15], s7 offen lds
    s_add_u32 m0, s40, 71680
    s_add_u32 s7, s41, 49152
    buffer_load_dwordx4 v233, s[12:15], s7 offen lds
    s_add_u32 m0, s40, 76800
    s_add_u32 s7, s41, 90112
    buffer_load_dwordx4 v233, s[12:15], s7 offen lds
    s_add_u32 m0, s40, 81920
    s_add_u32 s7, s41, 131072
    buffer_load_dwordx4 v233, s[12:15], s7 offen lds
    s_add_u32 m0, s40, 87040
    s_add_u32 s7, s41, 172032
    buffer_load_dwordx4 v233, s[12:15], s7 offen lds
    s_add_u32 m0, s40, 92160
    s_add_u32 s7, s41, 212992
    buffer_load_dwordx4 v233, s[12:15], s7 offen lds
    s_add_u32 m0, s40, 97280
    s_add_u32 s7, s41, 253952
    buffer_load_dwordx4 v233, s[12:15], s7 offen lds
    s_add_u32 m0, s40, 102400
    s_add_u32 s7, s41, 294912
    buffer_load_dwordx4 v233, s[12:15], s7 offen lds
    s_add_u32 m0, s40, 107520
    s_add_u32 s7, s41, 335872
    buffer_load_dwordx4 v233, s[12:15], s7 offen lds
    s_cmp_ge_u32 s6, 5
    s_cbranch_scc1 adaLN_cond__ssm_conv_h3__mixer_s_mlp__prompt_kernel_hq61
    s_add_u32 m0, s40, 112640
    s_add_u32 s7, s41, 376832
    buffer_load_dwordx4 v233, s[12:15], s7 offen lds
adaLN_cond__ssm_conv_h3__mixer_s_mlp__prompt_kernel_hq61:
    s_waitcnt vmcnt(9)
    s_branch adaLN_cond__ssm_conv_h3__mixer_s_mlp__prompt_kernel_hw58
adaLN_cond__ssm_conv_h3__mixer_s_mlp__prompt_kernel_hl57:
    s_cmp_lg_u32 s6, 3
    s_cbranch_scc1 adaLN_cond__ssm_conv_h3__mixer_s_mlp__prompt_kernel_ow62
    s_lshl_b32 s3, s4, 8
    s_add_u32 s3, s3, 4210688
    v_mov_b32 v252, s3
    s_add_u32 s3, s3, 128
    v_writelane_b32 v252, s3, 1
    s_lshl_b32 s3, s54, 8
    s_add_u32 s3, s3, 4218880
    v_writelane_b32 v252, s3, 2
    s_lshl_b32 s3, s56, 8
    s_add_u32 s3, s3, 4227072
    v_writelane_b32 v252, s3, 3
    s_add_u32 s3, s3, 8192
    v_writelane_b32 v252, s3, 4
    buffer_load_dword v251, v252, s[28:31], 0 offen sc1
adaLN_cond__ssm_conv_h3__mixer_s_mlp__prompt_kernel_ow62:
    s_cmp_lt_u32 s6, 4
    s_cbranch_scc1 adaLN_cond__ssm_conv_h3__mixer_s_mlp__prompt_kernel_hw58
    s_sub_u32 s3, s6, 4
    s_mul_i32 s3, s3, 20
    s_add_u32 s3, s3, s5
    s_sub_u32 s3, s3, 12
    s_lshl_b32 s3, s3, 3
    s_add_u32 s3, s3, s4
    s_cmp_ge_u32 s3, 448
    s_cbranch_scc1 adaLN_cond__ssm_conv_h3__mixer_s_mlp__prompt_kernel_hw58
    s_cmp_lt_u32 s3, 224
    s_cselect_b32 s8, s82, s84
    s_cselect_b32 s9, s83, s85
    s_cselect_b32 s7, 0, 224
    s_sub_u32 s3, s3, s7
    s_lshl_b32 s3, s3, 13
    s_mov_b32 s10, 1835008
    v_lshlrev_b32 v8, 7, v1
    buffer_load_dword v9, v8, s[8:11], s3 offen
adaLN_cond__ssm_conv_h3__mixer_s_mlp__prompt_kernel_hw58:
adaLN_cond__ssm_conv_h3__mixer_s_mlp__prompt_kernel_pj55:
    s_waitcnt lgkmcnt(0)
    s_barrier
    ds_read_b128 v[16:19], v52 offset:34816
    ds_read_b128 v[24:27], v52
    ds_read_b128 v[20:23], v55 offset:43008
    v_add_u32 v8, 161792, v232
    ds_read_b128 v[28:31], v8
    s_waitcnt lgkmcnt(3)
    buffer_store_dwordx4 v[16:19], v53, s[28:31], s21 offen sc1
    s_waitcnt lgkmcnt(1)
    buffer_store_dwordx4 v[24:27], v54, s[28:31], s59 offen sc1
    s_cmp_lg_u32 s24, 0
    s_cbranch_scc1 adaLN_cond__ssm_conv_h3__mixer_s_mlp__prompt_kernel_nh363
    buffer_store_dwordx4 v[20:23], v53, s[28:31], s20 offen sc1
adaLN_cond__ssm_conv_h3__mixer_s_mlp__prompt_kernel_nh363:
    s_cmp_lg_u32 s6, 7
    s_cbranch_scc1 adaLN_cond__ssm_conv_h3__mixer_s_mlp__prompt_kernel_ow64
    s_lshl_b32 s3, s48, 7
    s_add_u32 s3, s3, 5210112
    s_waitcnt lgkmcnt(0)
    s_mov_b64 s[46:47], exec
    s_mov_b64 exec, 0xff
    buffer_store_dwordx4 v[28:31], v232, s[28:31], s3 offen sc1
    s_mov_b64 exec, s[46:47]
adaLN_cond__ssm_conv_h3__mixer_s_mlp__prompt_kernel_ow64:
    v_mov_b32 v56, v224
    v_mov_b32 v57, v225
    v_mov_b32 v58, v226
    v_mov_b32 v59, v227
    v_lshrrev_b32 v8, 4, v1
    v_lshlrev_b32 v8, 4, v8
    s_lshl_b32 s3, s55, 8
    s_lshl_b32 s7, s25, 7
    s_add_u32 s3, s3, s7
    s_add_u32 s3, s3, 129024
    v_add_u32 v8, s3, v8
    ds_read_b128 v[200:203], v8
    ds_read_b128 v[204:207], v8 offset:64
    ds_read_b128 v[192:195], v8 offset:2048
    ds_read_b128 v[196:199], v8 offset:2112
    s_waitcnt lgkmcnt(0)
    ds_read_b64_tr_b16 v[64:65], v56 offset:0
    ds_read_b64_tr_b16 v[66:67], v56 offset:2048
    ds_read_b64_tr_b16 v[68:69], v57 offset:0
    ds_read_b64_tr_b16 v[70:71], v57 offset:2048
    ds_read_b64_tr_b16 v[72:73], v58 offset:0
    ds_read_b64_tr_b16 v[74:75], v58 offset:2048
    ds_read_b64_tr_b16 v[76:77], v59 offset:0
    ds_read_b64_tr_b16 v[78:79], v59 offset:2048
    ds_read_b64_tr_b16 v[80:81], v56 offset:4096
    ds_read_b64_tr_b16 v[82:83], v56 offset:6144
    ds_read_b64_tr_b16 v[84:85], v57 offset:4096
    ds_read_b64_tr_b16 v[86:87], v57 offset:6144
    ds_read_b64_tr_b16 v[88:89], v58 offset:4096
    ds_read_b64_tr_b16 v[90:91], v58 offset:6144
    s_waitcnt lgkmcnt(12)
    ds_read_b64_tr_b16 v[92:93], v59 offset:4096
    ds_read_b64_tr_b16 v[94:95], v59 offset:6144
    s_waitcnt lgkmcnt(12)
    ds_read_b64_tr_b16 v[96:97], v56 offset:8192
    ds_read_b64_tr_b16 v[98:99], v56 offset:10240
    s_waitcnt lgkmcnt(12)
    ds_read_b64_tr_b16 v[100:101], v57 offset:8192
    ds_read_b64_tr_b16 v[102:103], v57 offset:10240
    s_waitcnt lgkmcnt(12)
    ds_read_b64_tr_b16 v[104:105], v58 offset:8192
    ds_read_b64_tr_b16 v[106:107], v58 offset:10240
    s_waitcnt lgkmcnt(12)
    ds_read_b64_tr_b16 v[108:109], v59 offset:8192
    ds_read_b64_tr_b16 v[110:111], v59 offset:10240
    s_waitcnt lgkmcnt(12)
    ds_read_b64_tr_b16 v[112:113], v56 offset:12288
    ds_read_b64_tr_b16 v[114:115], v56 offset:14336
    s_waitcnt lgkmcnt(12)
    ds_read_b64_tr_b16 v[116:117], v57 offset:12288
    ds_read_b64_tr_b16 v[118:119], v57 offset:14336
    s_waitcnt lgkmcnt(12)
    ds_read_b64_tr_b16 v[120:121], v58 offset:12288
    ds_read_b64_tr_b16 v[122:123], v58 offset:14336
    s_waitcnt lgkmcnt(12)
    ds_read_b64_tr_b16 v[124:125], v59 offset:12288
    ds_read_b64_tr_b16 v[126:127], v59 offset:14336
    s_waitcnt lgkmcnt(12)
    ds_read_b64_tr_b16 v[128:129], v56 offset:16384
    ds_read_b64_tr_b16 v[130:131], v56 offset:18432
    s_waitcnt lgkmcnt(12)
    ds_read_b64_tr_b16 v[132:133], v57 offset:16384
    ds_read_b64_tr_b16 v[134:135], v57 offset:18432
    s_waitcnt lgkmcnt(12)
    ds_read_b64_tr_b16 v[136:137], v58 offset:16384
    ds_read_b64_tr_b16 v[138:139], v58 offset:18432
    s_waitcnt lgkmcnt(12)
    ds_read_b64_tr_b16 v[140:141], v59 offset:16384
    ds_read_b64_tr_b16 v[142:143], v59 offset:18432
    s_waitcnt lgkmcnt(12)
    ds_read_b64_tr_b16 v[144:145], v56 offset:20480
    ds_read_b64_tr_b16 v[146:147], v56 offset:22528
    s_waitcnt lgkmcnt(12)
    ds_read_b64_tr_b16 v[148:149], v57 offset:20480
    ds_read_b64_tr_b16 v[150:151], v57 offset:22528
    s_waitcnt lgkmcnt(12)
    ds_read_b64_tr_b16 v[152:153], v58 offset:20480
    ds_read_b64_tr_b16 v[154:155], v58 offset:22528
    s_waitcnt lgkmcnt(12)
    ds_read_b64_tr_b16 v[156:157], v59 offset:20480
    ds_read_b64_tr_b16 v[158:159], v59 offset:22528
    s_waitcnt lgkmcnt(12)
    ds_read_b64_tr_b16 v[160:161], v56 offset:24576
    ds_read_b64_tr_b16 v[162:163], v56 offset:26624
    s_waitcnt lgkmcnt(12)
    ds_read_b64_tr_b16 v[164:165], v57 offset:24576
    ds_read_b64_tr_b16 v[166:167], v57 offset:26624
    s_waitcnt lgkmcnt(12)
    ds_read_b64_tr_b16 v[168:169], v58 offset:24576
    ds_read_b64_tr_b16 v[170:171], v58 offset:26624
    s_waitcnt lgkmcnt(12)
    ds_read_b64_tr_b16 v[172:173], v59 offset:24576
    ds_read_b64_tr_b16 v[174:175], v59 offset:26624
    s_waitcnt lgkmcnt(12)
    ds_read_b64_tr_b16 v[176:177], v56 offset:28672
    ds_read_b64_tr_b16 v[178:179], v56 offset:30720
    s_waitcnt lgkmcnt(12)
    ds_read_b64_tr_b16 v[180:181], v57 offset:28672
    ds_read_b64_tr_b16 v[182:183], v57 offset:30720
    s_waitcnt lgkmcnt(12)
    ds_read_b64_tr_b16 v[184:185], v58 offset:28672
    ds_read_b64_tr_b16 v[186:187], v58 offset:30720
    s_waitcnt lgkmcnt(12)
    ds_read_b64_tr_b16 v[188:189], v59 offset:28672
    ds_read_b64_tr_b16 v[190:191], v59 offset:30720
    s_lshr_b32 s49, s55, 1
    s_lshr_b32 s3, s49, 1
    s_add_u32 s3, s3, 1
    s_sub_u32 s7, 0, s3
    s_bitcmp1_b32 s49, 0
    s_cselect_b32 s50, s3, s7
    v_and_b32 v60, 15, v1
    v_lshrrev_b32 v62, 4, v1
    v_mul_u32_u24 v2, 4352, v62
    v_lshl_add_u32 v2, v60, 4, v2
    s_and_b32 s3, s27, 15
    s_lshl_b32 s3, s3, 4
    s_add_u32 s3, s3, s50
    s_add_u32 s3, s3, 8
    s_lshl_b32 s3, s3, 4
    s_add_u32 s20, s58, s3
    s_mul_i32 s3, s25, 139264
    s_add_u32 s20, s20, s3
    s_lshl_b32 s3, s27, 4
    s_lshl_b32 s7, s55, 1
    s_add_u32 s3, s3, s7
    s_add_u32 s3, s3, s25
    s_lshl_b32 s48, s3, 10
    v_lshlrev_b32 v61, 3, v60
    v_lshlrev_b32 v62, 4, v62
    s_lshl_b32 s3, s55, 8
    s_lshl_b32 s7, s25, 7
    s_add_u32 s49, s3, s7
    s_lshl_b32 s3, s6, 11
    s_add_u32 s3, s3, 131072
    v_add_u32 v230, s3, v232
    v_xor_b32 v231, 8192, v230
    s_lshl_b32 s58, s4, 8
    s_add_u32 s58, s58, 4210688
    s_lshl_b32 s3, s5, 3
    s_add_u32 s59, s58, s3
    s_and_b32 s3, s5, 24
    s_sub_u32 s3, s3, 1
    v_min_u32 v252, 9, v1
    v_add_u32 v252, s3, v252
    v_med3_i32 v3, v252, 0, 31
    s_waitcnt vmcnt(0) lgkmcnt(0)
    s_barrier
    s_cmp_lg_u32 s6, 0
    s_cbranch_scc1 adaLN_cond__ssm_conv_h3__mixer_s_mlp__prompt_kernel_ow65
    v_mov_b32 v252, s59
    s_mov_b64 s[46:47], exec
    s_mov_b64 exec, 1
    buffer_store_dwordx2 v[248:249], v252, s[28:31], 0 offen
    s_mov_b64 exec, s[46:47]
    s_mov_b32 s44, 1
adaLN_cond__ssm_conv_h3__mixer_s_mlp__prompt_kernel_ow65:
    s_add_u32 m0, s23, 114688
    s_add_u32 s7, s36, 393216
    buffer_load_dwordx4 v233, s[12:15], s7 offen lds
    s_add_u32 m0, s23, 122880
    s_add_u32 s7, s36, 458752
    buffer_load_dwordx4 v233, s[12:15], s7 offen lds
    s_add_u32 m0, s23, 0
    s_add_u32 s7, s37, 0
    buffer_load_dwordx4 v234, s[60:63], s7 offen lds
    s_cmp_lg_u32 s6, 0
    s_cbranch_scc1 adaLN_cond__ssm_conv_h3__mixer_s_mlp__prompt_kernel_ow66
    v_lshlrev_b32 v252, 3, v3
    s_mov_b32 s45, 0
adaLN_cond__ssm_conv_h3__mixer_s_mlp__prompt_kernel_pl67:
    buffer_load_dwordx2 v[250:251], v252, s[28:31], s58 offen sc1
    s_waitcnt vmcnt(0)
    v_cmp_ne_u64 vcc, v[248:249], v[250:251]
    s_cbranch_vccz adaLN_cond__ssm_conv_h3__mixer_s_mlp__prompt_kernel_ple68
    s_add_u32 s45, s45, 1
    s_cmp_lt_u32 s45, 48
    s_cbranch_scc1 adaLN_cond__ssm_conv_h3__mixer_s_mlp__prompt_kernel_pl67
    s_mov_b64 s[40:41], vcc
    s_cmp_eq_u32 s44, 0
    s_cbranch_scc1 adaLN_cond__ssm_conv_h3__mixer_s_mlp__prompt_kernel_gf70
    s_lshl_b32 s3, s4, 5
    s_add_u32 s3, s3, s5
    s_lshl_b32 s3, s3, 7
    s_add_u32 s3, s3, 4325376
    v_lshlrev_b32 v253, 3, v1
    s_mov_b64 s[46:47], exec
    s_mov_b64 exec, 0xffff
    buffer_store_dwordx2 v[248:249], v253, s[28:31], s3 offen sc1
    s_mov_b64 exec, s[46:47]
    s_mov_b32 s44, 0
adaLN_cond__ssm_conv_h3__mixer_s_mlp__prompt_kernel_gf70:
    s_lshl_b32 s3, s4, 5
    s_lshl_b32 s3, s3, 7
    s_add_u32 s3, s3, 4325376
    v_lshlrev_b32 v253, 4, v252
    buffer_load_dwordx2 v[250:251], v253, s[28:31], s3 offen sc1
    s_waitcnt vmcnt(0)
    v_cmp_ne_u64 vcc, v[248:249], v[250:251]
    s_nop 0
    s_and_b64 vcc, vcc, s[40:41]
    s_cbranch_vccz adaLN_cond__ssm_conv_h3__mixer_s_mlp__prompt_kernel_ple68
    s_cmp_lt_u32 s45, 2000000
    s_cbranch_scc1 adaLN_cond__ssm_conv_h3__mixer_s_mlp__prompt_kernel_pl67
adaLN_cond__ssm_conv_h3__mixer_s_mlp__prompt_kernel_ple68:
adaLN_cond__ssm_conv_h3__mixer_s_mlp__prompt_kernel_ow66:
    s_barrier
    buffer_load_dwordx4 v[8:11], v2, s[28:31], s20 offen sc1
    s_add_u32 s20, s20, 17408
    buffer_load_dwordx4 v[12:15], v2, s[28:31], s20 offen sc1
    s_add_u32 s20, s20, 17408
    buffer_load_dwordx4 v[16:19], v2, s[28:31], s20 offen sc1
    s_add_u32 s20, s20, 17408
    buffer_load_dwordx4 v[20:23], v2, s[28:31], s20 offen sc1
    s_add_u32 s20, s20, 17408
    buffer_load_dwordx4 v[24:27], v2, s[28:31], s20 offen sc1
    s_add_u32 s20, s20, 17408
    buffer_load_dwordx4 v[28:31], v2, s[28:31], s20 offen sc1
    s_add_u32 s20, s20, 17408
    buffer_load_dwordx4 v[32:35], v2, s[28:31], s20 offen sc1
    s_add_u32 s20, s20, 17408
    buffer_load_dwordx4 v[36:39], v2, s[28:31], s20 offen sc1
    s_add_u32 s20, s20, 17408
    s_lshl_b32 s3, s27, 4
    s_add_u32 s3, s3, s50
    v_add_u32 v3, s3, v60
    v_cmp_gt_u32 vcc, 2048, v3
    s_waitcnt vmcnt(7)
    v_mfma_f32_16x16x32_bf16 v[40:43], v[64:67], v[8:11], 0
    v_mfma_f32_16x16x32_bf16 v[44:47], v[68:71], v[8:11], 0
    v_mfma_f32_16x16x32_bf16 v[48:51], v[72:75], v[8:11], 0
    v_mfma_f32_16x16x32_bf16 v[52:55], v[76:79], v[8:11], 0
    s_waitcnt vmcnt(6)
    v_mfma_f32_16x16x32_bf16 v[40:43], v[80:83], v[12:15], v[40:43]
    v_mfma_f32_16x16x32_bf16 v[44:47], v[84:87], v[12:15], v[44:47]
    v_mfma_f32_16x16x32_bf16 v[48:51], v[88:91], v[12:15], v[48:51]
    v_mfma_f32_16x16x32_bf16 v[52:55], v[92:95], v[12:15], v[52:55]
    s_waitcnt vmcnt(5)
    v_mfma_f32_16x16x32_bf16 v[40:43], v[96:99], v[16:19], v[40:43]
    v_mfma_f32_16x16x32_bf16 v[44:47], v[100:103], v[16:19], v[44:47]
    v_mfma_f32_16x16x32_bf16 v[48:51], v[104:107], v[16:19], v[48:51]
    v_mfma_f32_16x16x32_bf16 v[52:55], v[108:111], v[16:19], v[52:55]
    s_waitcnt vmcnt(4)
    v_mfma_f32_16x16x32_bf16 v[40:43], v[112:115], v[20:23], v[40:43]
    v_mfma_f32_16x16x32_bf16 v[44:47], v[116:119], v[20:23], v[44:47]
    v_mfma_f32_16x16x32_bf16 v[48:51], v[120:123], v[20:23], v[48:51]
    v_mfma_f32_16x16x32_bf16 v[52:55], v[124:127], v[20:23], v[52:55]
    s_waitcnt vmcnt(3)
    v_mfma_f32_16x16x32_bf16 v[40:43], v[128:131], v[24:27], v[40:43]
    v_mfma_f32_16x16x32_bf16 v[44:47], v[132:135], v[24:27], v[44:47]
    v_mfma_f32_16x16x32_bf16 v[48:51], v[136:139], v[24:27], v[48:51]
    v_mfma_f32_16x16x32_bf16 v[52:55], v[140:143], v[24:27], v[52:55]
    s_waitcnt vmcnt(2)
    v_mfma_f32_16x16x32_bf16 v[40:43], v[144:147], v[28:31], v[40:43]
    v_mfma_f32_16x16x32_bf16 v[44:47], v[148:151], v[28:31], v[44:47]
    v_mfma_f32_16x16x32_bf16 v[48:51], v[152:155], v[28:31], v[48:51]
    v_mfma_f32_16x16x32_bf16 v[52:55], v[156:159], v[28:31], v[52:55]
    s_waitcnt vmcnt(1)
    v_mfma_f32_16x16x32_bf16 v[40:43], v[160:163], v[32:35], v[40:43]
    v_mfma_f32_16x16x32_bf16 v[44:47], v[164:167], v[32:35], v[44:47]
    v_mfma_f32_16x16x32_bf16 v[48:51], v[168:171], v[32:35], v[48:51]
    v_mfma_f32_16x16x32_bf16 v[52:55], v[172:175], v[32:35], v[52:55]
    s_add_u32 m0, s23, 8192
    s_add_u32 s7, s37, 229376
    buffer_load_dwordx4 v234, s[60:63], s7 offen lds
    s_waitcnt vmcnt(1)
    v_mfma_f32_16x16x32_bf16 v[40:43], v[176:179], v[36:39], v[40:43]
    v_mfma_f32_16x16x32_bf16 v[44:47], v[180:183], v[36:39], v[44:47]
    v_mfma_f32_16x16x32_bf16 v[48:51], v[184:187], v[36:39], v[48:51]
    v_mfma_f32_16x16x32_bf16 v[52:55], v[188:191], v[36:39], v[52:55]
    s_add_u32 m0, s23, 16384
    s_add_u32 s7, s37, 458752
    buffer_load_dwordx4 v234, s[60:63], s7 offen lds
    s_nop 3
    ds_write_b128 v230, v[48:51]
    ds_write_b128 v230, v[52:55] offset:1024
    s_add_u32 m0, s23, 24576
    s_add_u32 s7, s37, 688128
    buffer_load_dwordx4 v234, s[60:63], s7 offen lds
    s_add_u32 m0, s23, 32768
    s_add_u32 s7, s37, 917504
    buffer_load_dwordx4 v234, s[60:63], s7 offen lds
    s_cmp_lg_u32 s6, 0
    s_cbranch_scc1 adaLN_cond__ssm_conv_h3__mixer_s_mlp__prompt_kernel_ow71
    s_cmp_eq_u32 s44, 0
    s_cbranch_scc1 adaLN_cond__ssm_conv_h3__mixer_s_mlp__prompt_kernel_gf72
    s_lshl_b32 s3, s4, 5
    s_add_u32 s3, s3, s5
    s_lshl_b32 s3, s3, 7
    s_add_u32 s3, s3, 4325376
    v_lshlrev_b32 v253, 3, v1
    s_mov_b64 s[46:47], exec
    s_mov_b64 exec, 0xffff
    buffer_store_dwordx2 v[248:249], v253, s[28:31], s3 offen sc1
    s_mov_b64 exec, s[46:47]
    s_mov_b32 s44, 0
adaLN_cond__ssm_conv_h3__mixer_s_mlp__prompt_kernel_gf72:
adaLN_cond__ssm_conv_h3__mixer_s_mlp__prompt_kernel_ow71:
    s_waitcnt vmcnt(13)
    s_add_u32 s21, s48, 5242880
    s_waitcnt lgkmcnt(0)
    s_barrier
    ds_read_b128 v[48:51], v231
    ds_read_b128 v[52:55], v231 offset:1024
    s_waitcnt lgkmcnt(0)
    v_add_u32 v56, 65536, v56
    v_add_u32 v57, 65536, v57
    v_add_u32 v58, 65536, v58
    v_add_u32 v59, 65536, v59
    v_pk_add_f32 v[40:41], v[40:41], v[48:49]
    v_pk_add_f32 v[42:43], v[42:43], v[50:51]
    s_add_u32 m0, s23, 40960
    s_add_u32 s7, s37, 1146880
    buffer_load_dwordx4 v234, s[60:63], s7 offen lds
    v_pk_add_f32 v[44:45], v[44:45], v[52:53]
    v_pk_add_f32 v[46:47], v[46:47], v[54:55]
    ds_read_b64_tr_b16 v[64:65], v56 offset:0
    ds_read_b64_tr_b16 v[66:67], v56 offset:2048
    v_pk_mul_f32 v[48:49], v[40:41], v[40:41]
    v_pk_mul_f32 v[50:51], v[42:43], v[42:43]
    v_pk_mul_f32 v[52:53], v[44:45], v[44:45]
    s_add_u32 m0, s23, 49152
    s_add_u32 s7, s37, 1376256
    buffer_load_dwordx4 v234, s[60:63], s7 offen lds
    v_pk_mul_f32 v[54:55], v[46:47], v[46:47]
    ds_read_b64_tr_b16 v[68:69], v57 offset:0
    ds_read_b64_tr_b16 v[70:71], v57 offset:2048
    v_pk_fma_f32 v[48:49], v[48:49], s[52:53], v[236:237] op_sel_hi:[1,1,0]
    v_pk_fma_f32 v[50:51], v[50:51], s[52:53], v[236:237] op_sel_hi:[1,1,0]
    v_pk_fma_f32 v[52:53], v[52:53], s[52:53], v[236:237] op_sel_hi:[1,1,0]
    v_pk_fma_f32 v[54:55], v[54:55], s[52:53], v[236:237] op_sel_hi:[1,1,0]
    s_add_u32 m0, s23, 57344
    s_add_u32 s7, s37, 1605632
    buffer_load_dwordx4 v234, s[60:63], s7 offen lds
    ds_read_b64_tr_b16 v[72:73], v58 offset:0
    ds_read_b64_tr_b16 v[74:75], v58 offset:2048
    v_pk_mul_f32 v[48:49], v[48:49], v[40:41]
    v_pk_mul_f32 v[50:51], v[50:51], v[42:43]
    v_pk_mul_f32 v[52:53], v[52:53], v[44:45]
    v_pk_mul_f32 v[54:55], v[54:55], v[46:47]
    ds_read_b64_tr_b16 v[76:77], v59 offset:0
    ds_read_b64_tr_b16 v[78:79], v59 offset:2048
    v_exp_f32 v48, v48
    v_exp_f32 v49, v49
    v_exp_f32 v50, v50
    v_exp_f32 v51, v51
    ds_read_b64_tr_b16 v[80:81], v56 offset:4096
    ds_read_b64_tr_b16 v[82:83], v56 offset:6144
    v_exp_f32 v52, v52
    v_exp_f32 v53, v53
    v_exp_f32 v54, v54
    v_exp_f32 v55, v55
    ds_read_b64_tr_b16 v[84:85], v57 offset:4096
    ds_read_b64_tr_b16 v[86:87], v57 offset:6144
    v_pk_add_f32 v[48:49], v[48:49], 1.0 op_sel_hi:[1,0]
    v_pk_add_f32 v[50:51], v[50:51], 1.0 op_sel_hi:[1,0]
    v_pk_add_f32 v[52:53], v[52:53], 1.0 op_sel_hi:[1,0]
    v_pk_add_f32 v[54:55], v[54:55], 1.0 op_sel_hi:[1,0]
    ds_read_b64_tr_b16 v[88:89], v58 offset:4096
    ds_read_b64_tr_b16 v[90:91], v58 offset:6144
    v_rcp_f32 v48, v48
    v_rcp_f32 v49, v49
    v_rcp_f32 v50, v50
    v_rcp_f32 v51, v51
    s_waitcnt lgkmcnt(12)
    ds_read_b64_tr_b16 v[92:93], v59 offset:4096
    ds_read_b64_tr_b16 v[94:95], v59 offset:6144
    v_rcp_f32 v52, v52
    v_rcp_f32 v53, v53
    v_rcp_f32 v54, v54
    v_rcp_f32 v55, v55
    s_waitcnt lgkmcnt(12)
    ds_read_b64_tr_b16 v[96:97], v56 offset:8192
    ds_read_b64_tr_b16 v[98:99], v56 offset:10240
    v_pk_mul_f32 v[40:41], v[40:41], v[48:49]
    v_pk_mul_f32 v[42:43], v[42:43], v[50:51]
    v_pk_mul_f32 v[44:45], v[44:45], v[52:53]
    v_pk_mul_f32 v[46:47], v[46:47], v[54:55]
    s_waitcnt lgkmcnt(12)
    ds_read_b64_tr_b16 v[100:101], v57 offset:8192
    ds_read_b64_tr_b16 v[102:103], v57 offset:10240
    v_cvt_pk_bf16_f32 v48, v40, v41
    v_cvt_pk_bf16_f32 v49, v42, v43
    v_cvt_pk_bf16_f32 v50, v44, v45
    v_cvt_pk_bf16_f32 v51, v46, v47
    s_waitcnt lgkmcnt(12)
    ds_read_b64_tr_b16 v[104:105], v58 offset:8192
    ds_read_b64_tr_b16 v[106:107], v58 offset:10240
    v_cndmask_b32 v48, 0, v48, vcc
    v_cndmask_b32 v49, 0, v49, vcc
    v_cndmask_b32 v50, 0, v50, vcc
    v_cndmask_b32 v51, 0, v51, vcc
    s_waitcnt lgkmcnt(12)
    ds_read_b64_tr_b16 v[108:109], v59 offset:8192
    ds_read_b64_tr_b16 v[110:111], v59 offset:10240
    buffer_store_dwordx4 v[48:51], v232, s[28:31], s21 offen sc1
    s_waitcnt lgkmcnt(0)
    ds_read_b64_tr_b16 v[112:113], v56 offset:12288
    ds_read_b64_tr_b16 v[114:115], v56 offset:14336
    ds_read_b64_tr_b16 v[116:117], v57 offset:12288
    ds_read_b64_tr_b16 v[118:119], v57 offset:14336
    ds_read_b64_tr_b16 v[120:121], v58 offset:12288
    ds_read_b64_tr_b16 v[122:123], v58 offset:14336
    ds_read_b64_tr_b16 v[124:125], v59 offset:12288
    ds_read_b64_tr_b16 v[126:127], v59 offset:14336
    ds_read_b64_tr_b16 v[128:129], v56 offset:16384
    ds_read_b64_tr_b16 v[130:131], v56 offset:18432
    ds_read_b64_tr_b16 v[132:133], v57 offset:16384
    ds_read_b64_tr_b16 v[134:135], v57 offset:18432
    ds_read_b64_tr_b16 v[136:137], v58 offset:16384
    ds_read_b64_tr_b16 v[138:139], v58 offset:18432
    s_waitcnt lgkmcnt(12)
    ds_read_b64_tr_b16 v[140:141], v59 offset:16384
    ds_read_b64_tr_b16 v[142:143], v59 offset:18432
    s_waitcnt lgkmcnt(12)
    ds_read_b64_tr_b16 v[144:145], v56 offset:20480
    ds_read_b64_tr_b16 v[146:147], v56 offset:22528
    s_waitcnt lgkmcnt(12)
    ds_read_b64_tr_b16 v[148:149], v57 offset:20480
    ds_read_b64_tr_b16 v[150:151], v57 offset:22528
    s_waitcnt lgkmcnt(12)
    ds_read_b64_tr_b16 v[152:153], v58 offset:20480
    ds_read_b64_tr_b16 v[154:155], v58 offset:22528
    s_waitcnt lgkmcnt(12)
    ds_read_b64_tr_b16 v[156:157], v59 offset:20480
    ds_read_b64_tr_b16 v[158:159], v59 offset:22528
    s_waitcnt lgkmcnt(12)
    ds_read_b64_tr_b16 v[160:161], v56 offset:24576
    ds_read_b64_tr_b16 v[162:163], v56 offset:26624
    s_waitcnt lgkmcnt(12)
    ds_read_b64_tr_b16 v[164:165], v57 offset:24576
    ds_read_b64_tr_b16 v[166:167], v57 offset:26624
    s_waitcnt lgkmcnt(12)
    ds_read_b64_tr_b16 v[168:169], v58 offset:24576
    ds_read_b64_tr_b16 v[170:171], v58 offset:26624
    s_waitcnt lgkmcnt(12)
    ds_read_b64_tr_b16 v[172:173], v59 offset:24576
    ds_read_b64_tr_b16 v[174:175], v59 offset:26624
    s_waitcnt lgkmcnt(12)
    ds_read_b64_tr_b16 v[176:177], v56 offset:28672
    ds_read_b64_tr_b16 v[178:179], v56 offset:30720
    s_waitcnt lgkmcnt(12)
    ds_read_b64_tr_b16 v[180:181], v57 offset:28672
    ds_read_b64_tr_b16 v[182:183], v57 offset:30720
    s_waitcnt lgkmcnt(12)
    ds_read_b64_tr_b16 v[184:185], v58 offset:28672
    ds_read_b64_tr_b16 v[186:187], v58 offset:30720
    s_waitcnt lgkmcnt(12)
    ds_read_b64_tr_b16 v[188:189], v59 offset:28672
    ds_read_b64_tr_b16 v[190:191], v59 offset:30720
    s_lshl_b32 s3, s27, 4
    s_lshl_b32 s7, s25, 3
    s_add_u32 s3, s3, s7
    s_lshl_b32 s3, s3, 10
    s_add_u32 s20, s3, 5242880
    s_add_u32 s21, s20, 4096
    s_lshl_b32 s58, s54, 8
    s_add_u32 s58, s58, 4218880
    s_lshl_b32 s3, s55, 3
    s_add_u32 s59, s58, s3
    s_and_b32 s24, s5, 24
    s_waitcnt vmcnt(0) lgkmcnt(0)
    s_barrier
    s_cmp_lg_u32 s6, 0
    s_cbranch_scc1 adaLN_cond__ssm_conv_h3__mixer_s_mlp__prompt_kernel_ow73
    v_mov_b32 v252, s59
    s_mov_b64 s[46:47], exec
    s_mov_b64 exec, 1
    buffer_store_dwordx2 v[248:249], v252, s[28:31], 0 offen
    s_mov_b64 exec, s[46:47]
    s_mov_b32 s44, 1
adaLN_cond__ssm_conv_h3__mixer_s_mlp__prompt_kernel_ow73:
    s_add_u32 m0, s23, 65536
    s_add_u32 s7, s37, 128
    buffer_load_dwordx4 v234, s[60:63], s7 offen lds
    s_add_u32 m0, s23, 73728
    s_add_u32 s7, s37, 229504
    buffer_load_dwordx4 v234, s[60:63], s7 offen lds
    s_add_u32 m0, s23, 81920
    s_add_u32 s7, s37, 458880
    buffer_load_dwordx4 v234, s[60:63], s7 offen lds
    s_cmp_lg_u32 s6, 0
    s_cbranch_scc1 adaLN_cond__ssm_conv_h3__mixer_s_mlp__prompt_kernel_ow74
    v_min_u32 v252, 7, v1
    v_lshlrev_b32 v252, 3, v252
    s_mov_b32 s45, 0
adaLN_cond__ssm_conv_h3__mixer_s_mlp__prompt_kernel_pl75:
    buffer_load_dwordx2 v[250:251], v252, s[28:31], s58 offen sc1
    s_waitcnt vmcnt(0)
    v_cmp_ne_u64 vcc, v[248:249], v[250:251]
    s_cbranch_vccz adaLN_cond__ssm_conv_h3__mixer_s_mlp__prompt_kernel_ple76
    s_add_u32 s45, s45, 1
    s_cmp_lt_u32 s45, 48
    s_cbranch_scc1 adaLN_cond__ssm_conv_h3__mixer_s_mlp__prompt_kernel_pl75
    s_mov_b64 s[40:41], vcc
    s_cmp_eq_u32 s44, 0
    s_cbranch_scc1 adaLN_cond__ssm_conv_h3__mixer_s_mlp__prompt_kernel_gf78
    s_lshl_b32 s3, s4, 5
    s_add_u32 s3, s3, s5
    s_lshl_b32 s3, s3, 7
    s_add_u32 s3, s3, 4358144
    v_lshlrev_b32 v253, 3, v1
    s_mov_b64 s[46:47], exec
    s_mov_b64 exec, 0xffff
    buffer_store_dwordx2 v[248:249], v253, s[28:31], s3 offen sc1
    s_mov_b64 exec, s[46:47]
    s_mov_b32 s44, 0
adaLN_cond__ssm_conv_h3__mixer_s_mlp__prompt_kernel_gf78:
    s_lshl_b32 s3, s4, 5
    s_add_u32 s3, s3, s24
    s_lshl_b32 s3, s3, 7
    s_add_u32 s3, s3, 4358144
    v_lshlrev_b32 v253, 4, v252
    buffer_load_dwordx2 v[250:251], v253, s[28:31], s3 offen sc1
    s_waitcnt vmcnt(0)
    v_cmp_ne_u64 vcc, v[248:249], v[250:251]
    s_nop 0
    s_and_b64 vcc, vcc, s[40:41]
    s_cbranch_vccz adaLN_cond__ssm_conv_h3__mixer_s_mlp__prompt_kernel_ple76
    s_cmp_lt_u32 s45, 2000000
    s_cbranch_scc1 adaLN_cond__ssm_conv_h3__mixer_s_mlp__prompt_kernel_pl75
adaLN_cond__ssm_conv_h3__mixer_s_mlp__prompt_kernel_ple76:
adaLN_cond__ssm_conv_h3__mixer_s_mlp__prompt_kernel_ow74:
    s_barrier
    buffer_load_dwordx4 v[8:11], v232, s[28:31], s20 offen offset:0 sc1
    buffer_load_dwordx4 v[12:15], v232, s[28:31], s20 offen offset:1024 sc1
    buffer_load_dwordx4 v[16:19], v232, s[28:31], s20 offen offset:2048 sc1
    buffer_load_dwordx4 v[20:23], v232, s[28:31], s20 offen offset:3072 sc1
    buffer_load_dwordx4 v[24:27], v232, s[28:31], s21 offen offset:0 sc1
    buffer_load_dwordx4 v[28:31], v232, s[28:31], s21 offen offset:1024 sc1
    buffer_load_dwordx4 v[32:35], v232, s[28:31], s21 offen offset:2048 sc1
    buffer_load_dwordx4 v[36:39], v232, s[28:31], s21 offen offset:3072 sc1
    s_add_u32 s3, s48, 9699328
    buffer_load_dwordx4 v[240:243], v232, s[28:31], s3 offen sc1
    s_lshl_b32 s3, s27, 8
    s_add_u32 s3, s3, 5210112
    v_lshlrev_b32 v59, 4, v60
    buffer_load_dwordx2 v[208:209], v59, s[28:31], s3 offen sc1
    s_waitcnt vmcnt(9)
    v_mfma_f32_16x16x32_bf16 v[40:43], v[64:67], v[8:11], 0
    v_mfma_f32_16x16x32_bf16 v[44:47], v[68:71], v[8:11], 0
    v_mfma_f32_16x16x32_bf16 v[48:51], v[72:75], v[8:11], 0
    v_mfma_f32_16x16x32_bf16 v[52:55], v[76:79], v[8:11], 0
    s_waitcnt vmcnt(8)
    v_mfma_f32_16x16x32_bf16 v[40:43], v[80:83], v[12:15], v[40:43]
    v_mfma_f32_16x16x32_bf16 v[44:47], v[84:87], v[12:15], v[44:47]
    v_mfma_f32_16x16x32_bf16 v[48:51], v[88:91], v[12:15], v[48:51]
    v_mfma_f32_16x16x32_bf16 v[52:55], v[92:95], v[12:15], v[52:55]
    s_waitcnt vmcnt(7)
    v_mfma_f32_16x16x32_bf16 v[40:43], v[96:99], v[16:19], v[40:43]
    v_mfma_f32_16x16x32_bf16 v[44:47], v[100:103], v[16:19], v[44:47]
    v_mfma_f32_16x16x32_bf16 v[48:51], v[104:107], v[16:19], v[48:51]
    v_mfma_f32_16x16x32_bf16 v[52:55], v[108:111], v[16:19], v[52:55]
    s_waitcnt vmcnt(6)
    v_mfma_f32_16x16x32_bf16 v[40:43], v[112:115], v[20:23], v[40:43]
    v_mfma_f32_16x16x32_bf16 v[44:47], v[116:119], v[20:23], v[44:47]
    v_mfma_f32_16x16x32_bf16 v[48:51], v[120:123], v[20:23], v[48:51]
    v_mfma_f32_16x16x32_bf16 v[52:55], v[124:127], v[20:23], v[52:55]
    s_waitcnt vmcnt(5)
    v_mfma_f32_16x16x32_bf16 v[40:43], v[128:131], v[24:27], v[40:43]
    v_mfma_f32_16x16x32_bf16 v[44:47], v[132:135], v[24:27], v[44:47]
    v_mfma_f32_16x16x32_bf16 v[48:51], v[136:139], v[24:27], v[48:51]
    v_mfma_f32_16x16x32_bf16 v[52:55], v[140:143], v[24:27], v[52:55]
    s_waitcnt vmcnt(4)
    v_mfma_f32_16x16x32_bf16 v[40:43], v[144:147], v[28:31], v[40:43]
    v_mfma_f32_16x16x32_bf16 v[44:47], v[148:151], v[28:31], v[44:47]
    v_mfma_f32_16x16x32_bf16 v[48:51], v[152:155], v[28:31], v[48:51]
    v_mfma_f32_16x16x32_bf16 v[52:55], v[156:159], v[28:31], v[52:55]
    s_waitcnt vmcnt(3)
    v_mfma_f32_16x16x32_bf16 v[40:43], v[160:163], v[32:35], v[40:43]
    v_mfma_f32_16x16x32_bf16 v[44:47], v[164:167], v[32:35], v[44:47]
    v_mfma_f32_16x16x32_bf16 v[48:51], v[168:171], v[32:35], v[48:51]
    v_mfma_f32_16x16x32_bf16 v[52:55], v[172:175], v[32:35], v[52:55]
    s_add_u32 m0, s23, 90112
    s_add_u32 s7, s37, 688256
    buffer_load_dwordx4 v234, s[60:63], s7 offen lds
    s_waitcnt vmcnt(3)
    v_mfma_f32_16x16x32_bf16 v[40:43], v[176:179], v[36:39], v[40:43]
    v_mfma_f32_16x16x32_bf16 v[44:47], v[180:183], v[36:39], v[44:47]
    v_mfma_f32_16x16x32_bf16 v[48:51], v[184:187], v[36:39], v[48:51]
    v_mfma_f32_16x16x32_bf16 v[52:55], v[188:191], v[36:39], v[52:55]
    s_add_u32 m0, s23, 98304
    s_add_u32 s7, s37, 917632
    buffer_load_dwordx4 v234, s[60:63], s7 offen lds
    s_nop 3
    ds_write_b128 v230, v[48:51]
    ds_write_b128 v230, v[52:55] offset:1024
    s_add_u32 m0, s23, 106496
    s_add_u32 s7, s37, 1147008
    buffer_load_dwordx4 v234, s[60:63], s7 offen lds
    s_add_u32 m0, s23, 114688
    s_add_u32 s7, s37, 1376384
    buffer_load_dwordx4 v234, s[60:63], s7 offen lds
    v_lshlrev_b32 v4, 3, v60
    v_lshrrev_b32 v5, 5, v1
    v_lshl_add_u32 v4, v5, 2, v4
    v_and_b32 v5, 16, v1
    v_lshl_add_u32 v4, v5, 26, v4
    s_lshr_b32 s3, s48, 3
    s_add_u32 s20, s3, 13893632
    s_add_u32 s21, s48, 11796480
    s_waitcnt vmcnt(4)
    v_lshlrev_b32 v8, 16, v240
    v_and_b32 v9, 0xffff0000, v240
    v_lshlrev_b32 v10, 16, v241
    v_and_b32 v11, 0xffff0000, v241
    v_lshlrev_b32 v12, 16, v242
    v_and_b32 v13, 0xffff0000, v242
    v_lshlrev_b32 v14, 16, v243
    v_and_b32 v15, 0xffff0000, v243
    v_pk_fma_f32 v[8:9], v[8:9], v[208:209], v[208:209] op_sel:[0,0,1] op_sel_hi:[1,0,1]
    v_pk_fma_f32 v[10:11], v[10:11], v[208:209], v[208:209] op_sel:[0,0,1] op_sel_hi:[1,0,1]
    v_pk_fma_f32 v[12:13], v[12:13], v[208:209], v[208:209] op_sel:[0,0,1] op_sel_hi:[1,0,1]
    v_pk_fma_f32 v[14:15], v[14:15], v[208:209], v[208:209] op_sel:[0,0,1] op_sel_hi:[1,0,1]
    v_pk_fma_f32 v[8:9], v[8:9], v[192:193], v[200:201]
    v_pk_fma_f32 v[10:11], v[10:11], v[194:195], v[202:203]
    v_pk_fma_f32 v[12:13], v[12:13], v[196:197], v[204:205]
    v_pk_fma_f32 v[14:15], v[14:15], v[198:199], v[206:207]
    s_waitcnt lgkmcnt(0)
    s_barrier
    ds_read_b128 v[48:51], v231
    ds_read_b128 v[52:55], v231 offset:1024
    s_add_u32 m0, s23, 122880
    s_add_u32 s7, s37, 1605760
    buffer_load_dwordx4 v234, s[60:63], s7 offen lds
    v_cvt_pk_bf16_f32 v16, v8, v9
    v_cvt_pk_bf16_f32 v17, v10, v11
    v_cvt_pk_bf16_f32 v18, v12, v13
    v_cvt_pk_bf16_f32 v19, v14, v15
    v_lshlrev_b32 v8, 16, v16
    v_and_b32 v9, 0xffff0000, v16
    v_lshlrev_b32 v10, 16, v17
    v_and_b32 v11, 0xffff0000, v17
    v_lshlrev_b32 v12, 16, v18
    v_and_b32 v13, 0xffff0000, v18
    v_lshlrev_b32 v14, 16, v19
    v_and_b32 v15, 0xffff0000, v19
    v_pk_add_f32 v[40:41], v[40:41], v[8:9]
    v_pk_add_f32 v[42:43], v[42:43], v[10:11]
    v_pk_add_f32 v[44:45], v[44:45], v[12:13]
    v_pk_add_f32 v[46:47], v[46:47], v[14:15]
    s_waitcnt lgkmcnt(0)
    v_pk_add_f32 v[40:41], v[40:41], v[48:49]
    v_pk_add_f32 v[42:43], v[42:43], v[50:51]
    v_pk_add_f32 v[44:45], v[44:45], v[52:53]
    v_pk_add_f32 v[46:47], v[46:47], v[54:55]
    v_cvt_pk_bf16_f32 v244, v40, v41
    v_cvt_pk_bf16_f32 v245, v42, v43
    v_cvt_pk_bf16_f32 v246, v44, v45
    v_cvt_pk_bf16_f32 v247, v46, v47
    buffer_store_dwordx4 v[244:247], v232, s[28:31], s21 offen sc1
    v_dot2_f32_bf16 v50, v244, s51, 0
    v_dot2_f32_bf16 v51, v244, v244, 0
    v_dot2_f32_bf16 v50, v245, s51, v50
    v_dot2_f32_bf16 v51, v245, v245, v51
    v_dot2_f32_bf16 v50, v246, s51, v50
    v_dot2_f32_bf16 v51, v246, v246, v51
    v_dot2_f32_bf16 v50, v247, s51, v50
    v_dot2_f32_bf16 v51, v247, v247, v51
    s_nop 2
    v_permlane32_swap_b32 v50, v51
    v_add_f32 v50, v50, v51
    v_mov_b32 v51, v50
    s_nop 1
    v_permlane16_swap_b32 v50, v51
    v_add_f32 v50, v50, v51
    buffer_store_dword v50, v4, s[28:31], s20 offen sc1
    s_mov_b32 s16, s84
    s_mov_b32 s17, s85
    s_mov_b32 s18, 1835008
    s_mov_b32 s19, 0x20000
    s_lshl_b32 s58, s56, 8
    s_add_u32 s58, s58, 4227072
    s_lshl_b32 s3, s57, 3
    s_add_u32 s59, s58, s3
    s_and_b32 s24, s5, 16
    s_and_b32 s3, s26, 1
    s_lshl_b32 s3, s3, 6
    v_xor_b32 v56, s3, v235
    s_lshr_b32 s3, s26, 1
    s_lshl_b32 s3, s3, 16
    v_add_u32 v56, s3, v56
    v_xor_b32 v57, 32, v56
    s_lshl_b32 s3, s25, 16
    v_add_u32 v58, s3, v232
    s_lshl_b32 s21, s25, 16
    s_lshl_b32 s3, s26, 12
    s_add_u32 s21, s21, s3
    s_lshl_b32 s20, s56, 17
    s_add_u32 s20, s20, s21
    s_add_u32 s20, s20, 11796480
    v_lshlrev_b32 v59, 3, v1
    s_lshl_b32 s22, s56, 14
    s_lshl_b32 s3, s6, 11
    s_add_u32 s22, s22, s3
    s_add_u32 s22, s22, 13893632
    s_lshl_b32 s3, s6, 7
    s_add_u32 s3, s3, 162816
    v_add_u32 v60, s3, v61
    s_lshl_b32 s3, s25, 9
    s_add_u32 s3, s3, 162816
    v_add_u32 v61, s3, v61
    s_lshl_b32 s50, s56, 3
    s_lshl_b32 s3, s25, 2
    s_add_u32 s50, s50, s3
    s_mul_i32 s50, s50, 56
    s_lshl_b32 s3, s57, 2
    s_add_u32 s50, s50, s3
    s_add_u32 s50, s50, s26
    s_lshl_b32 s50, s50, 10
    s_add_u32 s50, s50, 14680064
    v_mov_b32 v8, 1065369472
    v_mov_b32 v9, 1065369472
    v_mov_b32 v10, 1065369472
    v_mov_b32 v11, 1065369472
    s_bfe_u32 s3, s6, 0x10001
    s_lshl_b32 s3, s3, 11
    s_lshl_b32 s32, s39, 12
    s_add_u32 s32, s32, s3
    s_add_u32 s32, s32, 131072
    s_lshl_b32 s34, s25, 16
    s_and_b32 s7, s6, 1
    s_lshl_b32 s7, s7, 13
    s_add_u32 s34, s34, s7
    s_add_u32 s33, s34, s3
    s_lshr_b32 s3, s5, 3
    s_mul_i32 s7, s26, 458752
    s_lshl_b32 s42, s55, 7
    s_add_u32 s7, s7, s42
    s_mul_i32 s42, s3, 24576
    s_add_u32 s42, s42, s7
    s_lshl_b32 s43, s3, 15
    s_add_u32 s43, s43, s7
    s_add_u32 s43, s43, 98304
    v_lshlrev_b32 v2, 10, v1
    v_mov_b32 v3, 2147483648
    s_cmp_lt_u32 s6, 4
    s_cselect_b32 s3, 0, 32
    v_cmp_le_u32 vcc, s3, v1
    s_nop 1
    v_cndmask_b32 v2, v2, v3, vcc
    s_waitcnt vmcnt(2)
    s_barrier
    s_cmp_lg_u32 s6, 0
    s_cbranch_scc1 adaLN_cond__ssm_conv_h3__mixer_s_mlp__prompt_kernel_ow79
    s_cmp_eq_u32 s44, 0
    s_cbranch_scc1 adaLN_cond__ssm_conv_h3__mixer_s_mlp__prompt_kernel_gf80
    s_lshl_b32 s3, s4, 5
    s_add_u32 s3, s3, s5
    s_lshl_b32 s3, s3, 7
    s_add_u32 s3, s3, 4358144
    v_lshlrev_b32 v253, 3, v1
    s_mov_b64 s[46:47], exec
    s_mov_b64 exec, 0xffff
    buffer_store_dwordx2 v[248:249], v253, s[28:31], s3 offen sc1
    s_mov_b64 exec, s[46:47]
    s_mov_b32 s44, 0
adaLN_cond__ssm_conv_h3__mixer_s_mlp__prompt_kernel_gf80:
adaLN_cond__ssm_conv_h3__mixer_s_mlp__prompt_kernel_ow79:
    ds_read_b64_tr_b16 v[64:65], v56 offset:0
    ds_read_b64_tr_b16 v[66:67], v56 offset:2048
    ds_read_b64_tr_b16 v[68:69], v57 offset:0
    ds_read_b64_tr_b16 v[70:71], v57 offset:2048
    ds_read_b64_tr_b16 v[72:73], v56 offset:4096
    ds_read_b64_tr_b16 v[74:75], v56 offset:6144
    ds_read_b64_tr_b16 v[76:77], v57 offset:4096
    ds_read_b64_tr_b16 v[78:79], v57 offset:6144
    ds_read_b64_tr_b16 v[80:81], v56 offset:8192
    ds_read_b64_tr_b16 v[82:83], v56 offset:10240
    ds_read_b64_tr_b16 v[84:85], v57 offset:8192
    ds_read_b64_tr_b16 v[86:87], v57 offset:10240
    ds_read_b64_tr_b16 v[88:89], v56 offset:12288
    ds_read_b64_tr_b16 v[90:91], v56 offset:14336
    s_waitcnt lgkmcnt(12)
    ds_read_b64_tr_b16 v[92:93], v57 offset:12288
    ds_read_b64_tr_b16 v[94:95], v57 offset:14336
    s_waitcnt lgkmcnt(12)
    ds_read_b64_tr_b16 v[96:97], v56 offset:16384
    ds_read_b64_tr_b16 v[98:99], v56 offset:18432
    s_waitcnt lgkmcnt(12)
    ds_read_b64_tr_b16 v[100:101], v57 offset:16384
    ds_read_b64_tr_b16 v[102:103], v57 offset:18432
    s_waitcnt lgkmcnt(12)
    ds_read_b64_tr_b16 v[104:105], v56 offset:20480
    ds_read_b64_tr_b16 v[106:107], v56 offset:22528
    s_waitcnt lgkmcnt(12)
    ds_read_b64_tr_b16 v[108:109], v57 offset:20480
    ds_read_b64_tr_b16 v[110:111], v57 offset:22528
    s_waitcnt lgkmcnt(12)
    ds_read_b64_tr_b16 v[112:113], v56 offset:24576
    ds_read_b64_tr_b16 v[114:115], v56 offset:26624
    s_waitcnt lgkmcnt(12)
    ds_read_b64_tr_b16 v[116:117], v57 offset:24576
    ds_read_b64_tr_b16 v[118:119], v57 offset:26624
    s_waitcnt lgkmcnt(12)
    ds_read_b64_tr_b16 v[120:121], v56 offset:28672
    ds_read_b64_tr_b16 v[122:123], v56 offset:30720
    s_waitcnt lgkmcnt(12)
    ds_read_b64_tr_b16 v[124:125], v57 offset:28672
    ds_read_b64_tr_b16 v[126:127], v57 offset:30720
    s_waitcnt vmcnt(0)
    s_barrier
    s_cmp_lg_u32 s6, 0
    s_cbranch_scc1 adaLN_cond__ssm_conv_h3__mixer_s_mlp__prompt_kernel_ow83
    v_mov_b32 v252, s59
    s_mov_b64 s[46:47], exec
    s_mov_b64 exec, 1
    buffer_store_dwordx2 v[248:249], v252, s[28:31], 0 offen
    s_mov_b64 exec, s[46:47]
    s_mov_b32 s44, 1
adaLN_cond__ssm_conv_h3__mixer_s_mlp__prompt_kernel_ow83:
    s_cmp_ge_u32 s57, 14
    s_cbranch_scc1 adaLN_cond__ssm_conv_h3__mixer_s_mlp__prompt_kernel_idle381
    s_waitcnt lgkmcnt(0)
    ds_read_b64_tr_b16 v[128:129], v56 offset:32768
    ds_read_b64_tr_b16 v[130:131], v56 offset:34816
    v_mfma_f32_16x16x32_bf16 v[192:195], v[64:67], v[8:11], 0
    ds_read_b64_tr_b16 v[132:133], v57 offset:32768
    ds_read_b64_tr_b16 v[134:135], v57 offset:34816
    v_mfma_f32_16x16x32_bf16 v[196:199], v[68:71], v[8:11], 0
    ds_read_b64_tr_b16 v[136:137], v56 offset:36864
    ds_read_b64_tr_b16 v[138:139], v56 offset:38912
    v_mfma_f32_16x16x32_bf16 v[192:195], v[72:75], v[8:11], v[192:195]
    ds_read_b64_tr_b16 v[140:141], v57 offset:36864
    ds_read_b64_tr_b16 v[142:143], v57 offset:38912
    v_mfma_f32_16x16x32_bf16 v[196:199], v[76:79], v[8:11], v[196:199]
    ds_read_b64_tr_b16 v[144:145], v56 offset:40960
    ds_read_b64_tr_b16 v[146:147], v56 offset:43008
    v_mfma_f32_16x16x32_bf16 v[192:195], v[80:83], v[8:11], v[192:195]
    ds_read_b64_tr_b16 v[148:149], v57 offset:40960
    ds_read_b64_tr_b16 v[150:151], v57 offset:43008
    v_mfma_f32_16x16x32_bf16 v[196:199], v[84:87], v[8:11], v[196:199]
    ds_read_b64_tr_b16 v[152:153], v56 offset:45056
    ds_read_b64_tr_b16 v[154:155], v56 offset:47104
    v_mfma_f32_16x16x32_bf16 v[192:195], v[88:91], v[8:11], v[192:195]
    s_waitcnt lgkmcnt(12)
    ds_read_b64_tr_b16 v[156:157], v57 offset:45056
    ds_read_b64_tr_b16 v[158:159], v57 offset:47104
    v_mfma_f32_16x16x32_bf16 v[196:199], v[92:95], v[8:11], v[196:199]
    s_waitcnt lgkmcnt(12)
    ds_read_b64_tr_b16 v[160:161], v56 offset:49152
    ds_read_b64_tr_b16 v[162:163], v56 offset:51200
    v_mfma_f32_16x16x32_bf16 v[192:195], v[96:99], v[8:11], v[192:195]
    s_waitcnt lgkmcnt(12)
    ds_read_b64_tr_b16 v[164:165], v57 offset:49152
    ds_read_b64_tr_b16 v[166:167], v57 offset:51200
    v_mfma_f32_16x16x32_bf16 v[196:199], v[100:103], v[8:11], v[196:199]
    s_waitcnt lgkmcnt(12)
    ds_read_b64_tr_b16 v[168:169], v56 offset:53248
    ds_read_b64_tr_b16 v[170:171], v56 offset:55296
    v_mfma_f32_16x16x32_bf16 v[192:195], v[104:107], v[8:11], v[192:195]
    s_waitcnt lgkmcnt(12)
    ds_read_b64_tr_b16 v[172:173], v57 offset:53248
    ds_read_b64_tr_b16 v[174:175], v57 offset:55296
    v_mfma_f32_16x16x32_bf16 v[196:199], v[108:111], v[8:11], v[196:199]
    s_waitcnt lgkmcnt(12)
    ds_read_b64_tr_b16 v[176:177], v56 offset:57344
    ds_read_b64_tr_b16 v[178:179], v56 offset:59392
    v_mfma_f32_16x16x32_bf16 v[192:195], v[112:115], v[8:11], v[192:195]
    s_waitcnt lgkmcnt(12)
    ds_read_b64_tr_b16 v[180:181], v57 offset:57344
    ds_read_b64_tr_b16 v[182:183], v57 offset:59392
    v_mfma_f32_16x16x32_bf16 v[196:199], v[116:119], v[8:11], v[196:199]
    s_waitcnt lgkmcnt(12)
    ds_read_b64_tr_b16 v[184:185], v56 offset:61440
    ds_read_b64_tr_b16 v[186:187], v56 offset:63488
    v_mfma_f32_16x16x32_bf16 v[192:195], v[120:123], v[8:11], v[192:195]
    s_waitcnt lgkmcnt(12)
    ds_read_b64_tr_b16 v[188:189], v57 offset:61440
    ds_read_b64_tr_b16 v[190:191], v57 offset:63488
    v_mfma_f32_16x16x32_bf16 v[196:199], v[124:127], v[8:11], v[196:199]
    s_waitcnt lgkmcnt(12)
    s_cmp_lg_u32 s6, 0
    s_cbranch_scc1 adaLN_cond__ssm_conv_h3__mixer_s_mlp__prompt_kernel_ow84
    v_min_u32 v252, 15, v1
    v_lshlrev_b32 v252, 3, v252
    s_mov_b32 s45, 0
adaLN_cond__ssm_conv_h3__mixer_s_mlp__prompt_kernel_pl85:
    buffer_load_dwordx2 v[250:251], v252, s[28:31], s58 offen sc1
    s_waitcnt vmcnt(0)
    v_cmp_ne_u64 vcc, v[248:249], v[250:251]
    s_cbranch_vccz adaLN_cond__ssm_conv_h3__mixer_s_mlp__prompt_kernel_ple86
    s_add_u32 s45, s45, 1
    s_cmp_lt_u32 s45, 48
    s_cbranch_scc1 adaLN_cond__ssm_conv_h3__mixer_s_mlp__prompt_kernel_pl85
    s_mov_b64 s[40:41], vcc
    s_cmp_eq_u32 s44, 0
    s_cbranch_scc1 adaLN_cond__ssm_conv_h3__mixer_s_mlp__prompt_kernel_gf88
    s_lshl_b32 s3, s4, 5
    s_add_u32 s3, s3, s5
    s_lshl_b32 s3, s3, 7
    s_add_u32 s3, s3, 4390912
    v_lshlrev_b32 v253, 3, v1
    s_mov_b64 s[46:47], exec
    s_mov_b64 exec, 0xffff
    buffer_store_dwordx2 v[248:249], v253, s[28:31], s3 offen sc1
    s_mov_b64 exec, s[46:47]
    s_mov_b32 s44, 0
adaLN_cond__ssm_conv_h3__mixer_s_mlp__prompt_kernel_gf88:
    s_lshl_b32 s3, s4, 5
    s_add_u32 s3, s3, s24
    s_lshl_b32 s3, s3, 7
    s_add_u32 s3, s3, 4390912
    v_lshlrev_b32 v253, 4, v252
    buffer_load_dwordx2 v[250:251], v253, s[28:31], s3 offen sc1
    s_waitcnt vmcnt(0)
    v_cmp_ne_u64 vcc, v[248:249], v[250:251]
    s_nop 0
    s_and_b64 vcc, vcc, s[40:41]
    s_cbranch_vccz adaLN_cond__ssm_conv_h3__mixer_s_mlp__prompt_kernel_ple86
    s_cmp_lt_u32 s45, 2000000
    s_cbranch_scc1 adaLN_cond__ssm_conv_h3__mixer_s_mlp__prompt_kernel_pl85
adaLN_cond__ssm_conv_h3__mixer_s_mlp__prompt_kernel_ple86:
adaLN_cond__ssm_conv_h3__mixer_s_mlp__prompt_kernel_ow84:
    s_waitcnt lgkmcnt(0)
    s_barrier
    s_add_u32 m0, s21, 0
    s_add_u32 s35, s20, 0
    buffer_load_dwordx4 v232, s[28:31], s35 offen offset:0 sc1 lds
    buffer_load_dwordx4 v232, s[28:31], s35 offen offset:1024 sc1 lds
    buffer_load_dwordx4 v232, s[28:31], s35 offen offset:2048 sc1 lds
    buffer_load_dwordx4 v232, s[28:31], s35 offen offset:3072 sc1 lds
    s_barrier
    s_add_u32 m0, s21, 16384
    s_add_u32 s35, s20, 16384
    buffer_load_dwordx4 v232, s[28:31], s35 offen offset:0 sc1 lds
    buffer_load_dwordx4 v232, s[28:31], s35 offen offset:1024 sc1 lds
    buffer_load_dwordx4 v232, s[28:31], s35 offen offset:2048 sc1 lds
    buffer_load_dwordx4 v232, s[28:31], s35 offen offset:3072 sc1 lds
    buffer_load_dwordx2 v[40:41], v59, s[28:31], s22 offen offset:0 sc1
    buffer_load_dwordx2 v[42:43], v59, s[28:31], s22 offen offset:512 sc1
    buffer_load_dwordx2 v[44:45], v59, s[28:31], s22 offen offset:1024 sc1
    buffer_load_dwordx2 v[46:47], v59, s[28:31], s22 offen offset:1536 sc1
    v_mfma_f32_16x16x32_bf16 v[192:195], v[128:131], v[8:11], v[192:195]
    v_mfma_f32_16x16x32_bf16 v[196:199], v[132:135], v[8:11], v[196:199]
    v_mfma_f32_16x16x32_bf16 v[192:195], v[136:139], v[8:11], v[192:195]
    v_mfma_f32_16x16x32_bf16 v[196:199], v[140:143], v[8:11], v[196:199]
    v_mfma_f32_16x16x32_bf16 v[192:195], v[144:147], v[8:11], v[192:195]
    v_mfma_f32_16x16x32_bf16 v[196:199], v[148:151], v[8:11], v[196:199]
    v_mfma_f32_16x16x32_bf16 v[192:195], v[152:155], v[8:11], v[192:195]
    v_mfma_f32_16x16x32_bf16 v[196:199], v[156:159], v[8:11], v[196:199]
    v_mfma_f32_16x16x32_bf16 v[192:195], v[160:163], v[8:11], v[192:195]
    v_mfma_f32_16x16x32_bf16 v[196:199], v[164:167], v[8:11], v[196:199]
    v_mfma_f32_16x16x32_bf16 v[192:195], v[168:171], v[8:11], v[192:195]
    v_mfma_f32_16x16x32_bf16 v[196:199], v[172:175], v[8:11], v[196:199]
    v_mfma_f32_16x16x32_bf16 v[192:195], v[176:179], v[8:11], v[192:195]
    v_mfma_f32_16x16x32_bf16 v[196:199], v[180:183], v[8:11], v[196:199]
    v_mfma_f32_16x16x32_bf16 v[192:195], v[184:187], v[8:11], v[192:195]
    v_mfma_f32_16x16x32_bf16 v[196:199], v[188:191], v[8:11], v[196:199]
    v_and_b32 v53, 7, v1
    v_lshlrev_b32 v53, 7, v53
    s_waitcnt vmcnt(8) lgkmcnt(0)
    s_barrier
    ds_read_b128 v[8:11], v58 offset:0
    ds_read_b128 v[12:15], v58 offset:1024
    ds_read_b128 v[16:19], v58 offset:2048
    ds_read_b128 v[20:23], v58 offset:3072
    ds_read_b128 v[24:27], v58 offset:4096
    ds_read_b128 v[28:31], v58 offset:5120
    s_waitcnt lgkmcnt(5)
    v_mfma_f32_16x16x32_bf16 v[200:203], v[64:67], v[8:11], 0
    v_mfma_f32_16x16x32_bf16 v[204:207], v[68:71], v[8:11], 0
    ds_read_b128 v[32:35], v58 offset:6144
    s_add_u32 m0, s21, 32768
    s_add_u32 s35, s20, 32768
    buffer_load_dwordx4 v232, s[28:31], s35 offen offset:0 sc1 lds
    buffer_load_dwordx4 v232, s[28:31], s35 offen offset:1024 sc1 lds
    buffer_load_dwordx4 v232, s[28:31], s35 offen offset:2048 sc1 lds
    buffer_load_dwordx4 v232, s[28:31], s35 offen offset:3072 sc1 lds
    s_waitcnt lgkmcnt(5)
    v_mfma_f32_16x16x32_bf16 v[200:203], v[72:75], v[12:15], v[200:203]
    v_mfma_f32_16x16x32_bf16 v[204:207], v[76:79], v[12:15], v[204:207]
    ds_read_b128 v[36:39], v58 offset:7168
    s_waitcnt lgkmcnt(5)
    v_mfma_f32_16x16x32_bf16 v[200:203], v[80:83], v[16:19], v[200:203]
    v_mfma_f32_16x16x32_bf16 v[204:207], v[84:87], v[16:19], v[204:207]
    ds_read_b128 v[8:11], v58 offset:8192
    s_waitcnt lgkmcnt(5)
    v_mfma_f32_16x16x32_bf16 v[200:203], v[88:91], v[20:23], v[200:203]
    v_mfma_f32_16x16x32_bf16 v[204:207], v[92:95], v[20:23], v[204:207]
    ds_read_b128 v[12:15], v58 offset:9216
    s_waitcnt lgkmcnt(5)
    v_mfma_f32_16x16x32_bf16 v[200:203], v[96:99], v[24:27], v[200:203]
    v_mfma_f32_16x16x32_bf16 v[204:207], v[100:103], v[24:27], v[204:207]
    ds_read_b128 v[16:19], v58 offset:10240
    s_add_u32 m0, s21, 49152
    s_add_u32 s35, s20, 49152
    buffer_load_dwordx4 v232, s[28:31], s35 offen offset:0 sc1 lds
    buffer_load_dwordx4 v232, s[28:31], s35 offen offset:1024 sc1 lds
    buffer_load_dwordx4 v232, s[28:31], s35 offen offset:2048 sc1 lds
    buffer_load_dwordx4 v232, s[28:31], s35 offen offset:3072 sc1 lds
    s_waitcnt lgkmcnt(5)
    v_mfma_f32_16x16x32_bf16 v[200:203], v[104:107], v[28:31], v[200:203]
    v_mfma_f32_16x16x32_bf16 v[204:207], v[108:111], v[28:31], v[204:207]
    ds_read_b128 v[20:23], v58 offset:11264
    s_waitcnt lgkmcnt(5)
    v_mfma_f32_16x16x32_bf16 v[200:203], v[112:115], v[32:35], v[200:203]
    v_mfma_f32_16x16x32_bf16 v[204:207], v[116:119], v[32:35], v[204:207]
    ds_read_b128 v[24:27], v58 offset:12288
    s_waitcnt lgkmcnt(5)
    v_mfma_f32_16x16x32_bf16 v[200:203], v[120:123], v[36:39], v[200:203]
    v_mfma_f32_16x16x32_bf16 v[204:207], v[124:127], v[36:39], v[204:207]
    ds_read_b128 v[28:31], v58 offset:13312
    s_waitcnt lgkmcnt(5)
    v_mfma_f32_16x16x32_bf16 v[200:203], v[128:131], v[8:11], v[200:203]
    v_mfma_f32_16x16x32_bf16 v[204:207], v[132:135], v[8:11], v[204:207]
    ds_read_b128 v[32:35], v58 offset:14336
    buffer_load_dword v3, v2, s[16:19], s42 offen
    s_waitcnt lgkmcnt(5)
    v_mfma_f32_16x16x32_bf16 v[200:203], v[136:139], v[12:15], v[200:203]
    v_mfma_f32_16x16x32_bf16 v[204:207], v[140:143], v[12:15], v[204:207]
    ds_read_b128 v[36:39], v58 offset:15360
    s_waitcnt lgkmcnt(5)
    v_mfma_f32_16x16x32_bf16 v[200:203], v[144:147], v[16:19], v[200:203]
    v_mfma_f32_16x16x32_bf16 v[204:207], v[148:151], v[16:19], v[204:207]
    s_waitcnt lgkmcnt(4)
    v_mfma_f32_16x16x32_bf16 v[200:203], v[152:155], v[20:23], v[200:203]
    v_mfma_f32_16x16x32_bf16 v[204:207], v[156:159], v[20:23], v[204:207]
    s_waitcnt lgkmcnt(3)
    v_mfma_f32_16x16x32_bf16 v[200:203], v[160:163], v[24:27], v[200:203]
    v_mfma_f32_16x16x32_bf16 v[204:207], v[164:167], v[24:27], v[204:207]
    s_waitcnt lgkmcnt(2)
    v_mfma_f32_16x16x32_bf16 v[200:203], v[168:171], v[28:31], v[200:203]
    v_mfma_f32_16x16x32_bf16 v[204:207], v[172:175], v[28:31], v[204:207]
    s_waitcnt lgkmcnt(1)
    v_mfma_f32_16x16x32_bf16 v[200:203], v[176:179], v[32:35], v[200:203]
    v_mfma_f32_16x16x32_bf16 v[204:207], v[180:183], v[32:35], v[204:207]
    s_waitcnt lgkmcnt(0)
    v_mfma_f32_16x16x32_bf16 v[200:203], v[184:187], v[36:39], v[200:203]
    v_mfma_f32_16x16x32_bf16 v[204:207], v[188:191], v[36:39], v[204:207]
    s_waitcnt vmcnt(9)
    v_pk_add_f32 v[40:41], v[40:41], v[42:43]
    v_pk_add_f32 v[44:45], v[44:45], v[46:47]
    v_pk_add_f32 v[40:41], v[40:41], v[44:45]
    s_nop 1
    v_permlane32_swap_b32 v40, v41
    v_add_f32 v40, v40, v41
    v_mov_b32 v41, v40
    s_nop 1
    v_permlane16_swap_b32 v40, v41
    v_add_f32 v40, v40, v41
    v_mov_b32 v41, v40
    s_nop 1
    v_permlane32_swap_b32 v40, v41
    v_mul_f32 v40, 0x3b000000, v40
    v_mul_f32 v41, 0x3b000000, v41
    v_fma_f32 v41, -v40, v40, v41
    v_max_f32 v41, 0, v41
    v_add_f32 v41, 0x3727c5ac, v41
    v_rsq_f32 v42, v41
    s_nop 0
    v_mul_f32_e64 v43, -v40, v42
    ds_write_b64 v60, v[42:43]
    s_waitcnt vmcnt(13) lgkmcnt(0)
    s_barrier
    ds_read_b64 v[216:217], v61 offset:0
    ds_read_b64 v[218:219], v61 offset:128
    ds_read_b64 v[220:221], v61 offset:256
    ds_read_b64 v[222:223], v61 offset:384
    ds_read_b128 v[8:11], v58 offset:16384
    ds_read_b128 v[12:15], v58 offset:17408
    ds_read_b128 v[16:19], v58 offset:18432
    ds_read_b128 v[20:23], v58 offset:19456
    ds_read_b128 v[24:27], v58 offset:20480
    ds_read_b128 v[28:31], v58 offset:21504
    s_waitcnt lgkmcnt(5)
    v_mfma_f32_16x16x32_bf16 v[208:211], v[64:67], v[8:11], 0
    v_mfma_f32_16x16x32_bf16 v[212:215], v[68:71], v[8:11], 0
    ds_read_b128 v[32:35], v58 offset:22528
    s_waitcnt lgkmcnt(5)
    v_mfma_f32_16x16x32_bf16 v[208:211], v[72:75], v[12:15], v[208:211]
    v_mul_f32 v40, v192, v217
    v_mul_f32 v41, v193, v217
    v_mul_f32 v42, v194, v217
    v_mfma_f32_16x16x32_bf16 v[212:215], v[76:79], v[12:15], v[212:215]
    v_mul_f32 v43, v195, v217
    v_mul_f32 v44, v196, v217
    v_mul_f32 v45, v197, v217
    ds_read_b128 v[36:39], v58 offset:23552
    s_waitcnt lgkmcnt(5)
    v_mfma_f32_16x16x32_bf16 v[208:211], v[80:83], v[16:19], v[208:211]
    v_mul_f32 v46, v198, v217
    v_mul_f32 v47, v199, v217
    v_fma_f32 v200, v200, v216, v40
    v_mfma_f32_16x16x32_bf16 v[212:215], v[84:87], v[16:19], v[212:215]
    v_fma_f32 v201, v201, v216, v41
    v_fma_f32 v202, v202, v216, v42
    v_fma_f32 v203, v203, v216, v43
    ds_read_b128 v[8:11], v58 offset:24576
    s_waitcnt lgkmcnt(5)
    v_mfma_f32_16x16x32_bf16 v[208:211], v[88:91], v[20:23], v[208:211]
    v_fma_f32 v204, v204, v216, v44
    v_fma_f32 v205, v205, v216, v45
    v_fma_f32 v206, v206, v216, v46
    v_mfma_f32_16x16x32_bf16 v[212:215], v[92:95], v[20:23], v[212:215]
    v_fma_f32 v207, v207, v216, v47
    v_mul_f32 v40, v200, v200
    v_mul_f32 v41, v201, v201
    ds_read_b128 v[12:15], v58 offset:25600
    s_waitcnt lgkmcnt(5)
    v_mfma_f32_16x16x32_bf16 v[208:211], v[96:99], v[24:27], v[208:211]
    v_mul_f32 v42, v202, v202
    v_mul_f32 v43, v203, v203
    v_mul_f32 v44, v204, v204
    v_mfma_f32_16x16x32_bf16 v[212:215], v[100:103], v[24:27], v[212:215]
    v_mul_f32 v45, v205, v205
    v_mul_f32 v46, v206, v206
    v_mul_f32 v47, v207, v207
    ds_read_b128 v[16:19], v58 offset:26624
    s_waitcnt lgkmcnt(5)
    v_mfma_f32_16x16x32_bf16 v[208:211], v[104:107], v[28:31], v[208:211]
    v_fmaak_f32 v40, v40, v237, 0xc0135761
    v_fmaak_f32 v41, v41, v237, 0xc0135761
    v_fmaak_f32 v42, v42, v237, 0xc0135761
    v_mfma_f32_16x16x32_bf16 v[212:215], v[108:111], v[28:31], v[212:215]
    v_fmaak_f32 v43, v43, v237, 0xc0135761
    v_fmaak_f32 v44, v44, v237, 0xc0135761
    v_fmaak_f32 v45, v45, v237, 0xc0135761
    ds_read_b128 v[20:23], v58 offset:27648
    s_waitcnt lgkmcnt(5)
    v_mfma_f32_16x16x32_bf16 v[208:211], v[112:115], v[32:35], v[208:211]
    v_fmaak_f32 v46, v46, v237, 0xc0135761
    v_fmaak_f32 v47, v47, v237, 0xc0135761
    v_mul_f32 v40, v40, v200
    v_mfma_f32_16x16x32_bf16 v[212:215], v[116:119], v[32:35], v[212:215]
    v_mul_f32 v41, v41, v201
    v_mul_f32 v42, v42, v202
    v_mul_f32 v43, v43, v203
    ds_read_b128 v[24:27], v58 offset:28672
    s_add_u32 m0, s32, 0
    s_add_u32 s7, s38, 0
    buffer_load_dwordx4 v233, s[16:19], s7 offen lds
    s_add_u32 m0, s32, 1024
    s_add_u32 s7, s38, 8192
    buffer_load_dwordx4 v233, s[16:19], s7 offen lds
    s_waitcnt lgkmcnt(5)
    v_mfma_f32_16x16x32_bf16 v[208:211], v[120:123], v[36:39], v[208:211]
    v_mul_f32 v44, v44, v204
    v_mul_f32 v45, v45, v205
    v_mul_f32 v46, v46, v206
    v_mfma_f32_16x16x32_bf16 v[212:215], v[124:127], v[36:39], v[212:215]
    v_mul_f32 v47, v47, v207
    v_exp_f32 v40, v40
    v_exp_f32 v41, v41
    ds_read_b128 v[28:31], v58 offset:29696
    s_waitcnt lgkmcnt(5)
    v_mfma_f32_16x16x32_bf16 v[208:211], v[128:131], v[8:11], v[208:211]
    v_exp_f32 v42, v42
    v_exp_f32 v43, v43
    v_exp_f32 v44, v44
    v_mfma_f32_16x16x32_bf16 v[212:215], v[132:135], v[8:11], v[212:215]
    v_exp_f32 v45, v45
    v_exp_f32 v46, v46
    v_exp_f32 v47, v47
    ds_read_b128 v[32:35], v58 offset:30720
    s_add_u32 m0, s33, 0
    s_add_u32 s7, s38, 32768
    buffer_load_dwordx4 v233, s[16:19], s7 offen lds
    s_add_u32 m0, s33, 1024
    s_add_u32 s7, s38, 40960
    buffer_load_dwordx4 v233, s[16:19], s7 offen lds
    s_waitcnt lgkmcnt(5)
    v_mfma_f32_16x16x32_bf16 v[208:211], v[136:139], v[12:15], v[208:211]
    v_add_f32 v40, 1.0, v40
    v_add_f32 v41, 1.0, v41
    v_add_f32 v42, 1.0, v42
    v_mfma_f32_16x16x32_bf16 v[212:215], v[140:143], v[12:15], v[212:215]
    v_add_f32 v43, 1.0, v43
    v_add_f32 v44, 1.0, v44
    v_add_f32 v45, 1.0, v45
    ds_read_b128 v[36:39], v58 offset:31744
    s_waitcnt lgkmcnt(5)
    v_mfma_f32_16x16x32_bf16 v[208:211], v[144:147], v[16:19], v[208:211]
    v_add_f32 v46, 1.0, v46
    v_add_f32 v47, 1.0, v47
    v_rcp_f32 v40, v40
    v_mfma_f32_16x16x32_bf16 v[212:215], v[148:151], v[16:19], v[212:215]
    v_rcp_f32 v41, v41
    v_rcp_f32 v42, v42
    v_rcp_f32 v43, v43
    s_add_u32 m0, s33, 4096
    s_add_u32 s7, s38, 65536
    buffer_load_dwordx4 v233, s[16:19], s7 offen lds
    s_add_u32 m0, s33, 5120
    s_add_u32 s7, s38, 73728
    buffer_load_dwordx4 v233, s[16:19], s7 offen lds
    s_waitcnt lgkmcnt(4)
    v_mfma_f32_16x16x32_bf16 v[208:211], v[152:155], v[20:23], v[208:211]
    v_rcp_f32 v44, v44
    v_rcp_f32 v45, v45
    v_rcp_f32 v46, v46
    v_mfma_f32_16x16x32_bf16 v[212:215], v[156:159], v[20:23], v[212:215]
    v_rcp_f32 v47, v47
    v_mul_f32 v200, v200, v40
    v_mul_f32 v201, v201, v41
    s_waitcnt lgkmcnt(3)
    v_mfma_f32_16x16x32_bf16 v[208:211], v[160:163], v[24:27], v[208:211]
    v_mul_f32 v202, v202, v42
    v_mul_f32 v203, v203, v43
    v_mul_f32 v204, v204, v44
    v_mfma_f32_16x16x32_bf16 v[212:215], v[164:167], v[24:27], v[212:215]
    v_mul_f32 v205, v205, v45
    v_mul_f32 v206, v206, v46
    v_mul_f32 v207, v207, v47
    buffer_load_dword v3, v2, s[16:19], s43 offen
    s_waitcnt lgkmcnt(2)
    v_mfma_f32_16x16x32_bf16 v[208:211], v[168:171], v[28:31], v[208:211]
    v_cvt_pk_bf16_f32 v48, v200, v201
    v_cvt_pk_bf16_f32 v49, v202, v203
    v_cvt_pk_bf16_f32 v50, v204, v205
    v_mfma_f32_16x16x32_bf16 v[212:215], v[172:175], v[28:31], v[212:215]
    v_cvt_pk_bf16_f32 v51, v206, v207
    s_add_u32 s7, s50, 0
    buffer_store_dwordx4 v[48:51], v232, s[28:31], s7 offen sc1
    s_waitcnt lgkmcnt(1)
    v_mfma_f32_16x16x32_bf16 v[208:211], v[176:179], v[32:35], v[208:211]
    v_mfma_f32_16x16x32_bf16 v[212:215], v[180:183], v[32:35], v[212:215]
    s_waitcnt lgkmcnt(0)
    v_mfma_f32_16x16x32_bf16 v[208:211], v[184:187], v[36:39], v[208:211]
    v_mfma_f32_16x16x32_bf16 v[212:215], v[188:191], v[36:39], v[212:215]
    s_waitcnt vmcnt(13) lgkmcnt(0)
    s_barrier
    ds_read_b128 v[8:11], v58 offset:32768
    ds_read_b128 v[12:15], v58 offset:33792
    ds_read_b128 v[16:19], v58 offset:34816
    ds_read_b128 v[20:23], v58 offset:35840
    ds_read_b128 v[24:27], v58 offset:36864
    ds_read_b128 v[28:31], v58 offset:37888
    s_waitcnt lgkmcnt(5)
    v_mfma_f32_16x16x32_bf16 v[200:203], v[64:67], v[8:11], 0
    v_mfma_f32_16x16x32_bf16 v[204:207], v[68:71], v[8:11], 0
    ds_read_b128 v[32:35], v58 offset:38912
    s_waitcnt lgkmcnt(5)
    v_mfma_f32_16x16x32_bf16 v[200:203], v[72:75], v[12:15], v[200:203]
    v_mul_f32 v40, v192, v219
    v_mul_f32 v41, v193, v219
    v_mul_f32 v42, v194, v219
    v_mfma_f32_16x16x32_bf16 v[204:207], v[76:79], v[12:15], v[204:207]
    v_mul_f32 v43, v195, v219
    v_mul_f32 v44, v196, v219
    v_mul_f32 v45, v197, v219
    ds_read_b128 v[36:39], v58 offset:39936
    s_waitcnt lgkmcnt(5)
    v_mfma_f32_16x16x32_bf16 v[200:203], v[80:83], v[16:19], v[200:203]
    v_mul_f32 v46, v198, v219
    v_mul_f32 v47, v199, v219
    v_fma_f32 v208, v208, v218, v40
    v_mfma_f32_16x16x32_bf16 v[204:207], v[84:87], v[16:19], v[204:207]
    v_fma_f32 v209, v209, v218, v41
    v_fma_f32 v210, v210, v218, v42
    v_fma_f32 v211, v211, v218, v43
    ds_read_b128 v[8:11], v58 offset:40960
    s_waitcnt lgkmcnt(5)
    v_mfma_f32_16x16x32_bf16 v[200:203], v[88:91], v[20:23], v[200:203]
    v_fma_f32 v212, v212, v218, v44
    v_fma_f32 v213, v213, v218, v45
    v_fma_f32 v214, v214, v218, v46
    v_mfma_f32_16x16x32_bf16 v[204:207], v[92:95], v[20:23], v[204:207]
    v_fma_f32 v215, v215, v218, v47
    v_mul_f32 v40, v208, v208
    v_mul_f32 v41, v209, v209
    ds_read_b128 v[12:15], v58 offset:41984
    s_waitcnt lgkmcnt(5)
    v_mfma_f32_16x16x32_bf16 v[200:203], v[96:99], v[24:27], v[200:203]
    v_mul_f32 v42, v210, v210
    v_mul_f32 v43, v211, v211
    v_mul_f32 v44, v212, v212
    v_mfma_f32_16x16x32_bf16 v[204:207], v[100:103], v[24:27], v[204:207]
    v_mul_f32 v45, v213, v213
    v_mul_f32 v46, v214, v214
    v_mul_f32 v47, v215, v215
    ds_read_b128 v[16:19], v58 offset:43008
    s_waitcnt lgkmcnt(5)
    v_mfma_f32_16x16x32_bf16 v[200:203], v[104:107], v[28:31], v[200:203]
    v_fmaak_f32 v40, v40, v237, 0xc0135761
    v_fmaak_f32 v41, v41, v237, 0xc0135761
    v_fmaak_f32 v42, v42, v237, 0xc0135761
    v_mfma_f32_16x16x32_bf16 v[204:207], v[108:111], v[28:31], v[204:207]
    v_fmaak_f32 v43, v43, v237, 0xc0135761
    v_fmaak_f32 v44, v44, v237, 0xc0135761
    v_fmaak_f32 v45, v45, v237, 0xc0135761
    ds_read_b128 v[20:23], v58 offset:44032
    s_waitcnt lgkmcnt(5)
    v_mfma_f32_16x16x32_bf16 v[200:203], v[112:115], v[32:35], v[200:203]
    v_fmaak_f32 v46, v46, v237, 0xc0135761
    v_fmaak_f32 v47, v47, v237, 0xc0135761
    v_mul_f32 v40, v40, v208
    v_mfma_f32_16x16x32_bf16 v[204:207], v[116:119], v[32:35], v[204:207]
    v_mul_f32 v41, v41, v209
    v_mul_f32 v42, v42, v210
    v_mul_f32 v43, v43, v211
    ds_read_b128 v[24:27], v58 offset:45056
    s_waitcnt lgkmcnt(5)
    v_mfma_f32_16x16x32_bf16 v[200:203], v[120:123], v[36:39], v[200:203]
    v_mul_f32 v44, v44, v212
    v_mul_f32 v45, v45, v213
    v_mul_f32 v46, v46, v214
    v_mfma_f32_16x16x32_bf16 v[204:207], v[124:127], v[36:39], v[204:207]
    v_mul_f32 v47, v47, v215
    v_exp_f32 v40, v40
    v_exp_f32 v41, v41
    ds_read_b128 v[28:31], v58 offset:46080
    s_waitcnt lgkmcnt(5)
    v_mfma_f32_16x16x32_bf16 v[200:203], v[128:131], v[8:11], v[200:203]
    v_exp_f32 v42, v42
    v_exp_f32 v43, v43
    v_exp_f32 v44, v44
    v_mfma_f32_16x16x32_bf16 v[204:207], v[132:135], v[8:11], v[204:207]
    v_exp_f32 v45, v45
    v_exp_f32 v46, v46
    v_exp_f32 v47, v47
    ds_read_b128 v[32:35], v58 offset:47104
    s_waitcnt lgkmcnt(5)
    v_mfma_f32_16x16x32_bf16 v[200:203], v[136:139], v[12:15], v[200:203]
    v_add_f32 v40, 1.0, v40
    v_add_f32 v41, 1.0, v41
    v_add_f32 v42, 1.0, v42
    v_mfma_f32_16x16x32_bf16 v[204:207], v[140:143], v[12:15], v[204:207]
    v_add_f32 v43, 1.0, v43
    v_add_f32 v44, 1.0, v44
    v_add_f32 v45, 1.0, v45
    ds_read_b128 v[36:39], v58 offset:48128
    s_waitcnt lgkmcnt(5)
    v_mfma_f32_16x16x32_bf16 v[200:203], v[144:147], v[16:19], v[200:203]
    v_add_f32 v46, 1.0, v46
    v_add_f32 v47, 1.0, v47
    v_rcp_f32 v40, v40
    v_mfma_f32_16x16x32_bf16 v[204:207], v[148:151], v[16:19], v[204:207]
    v_rcp_f32 v41, v41
    v_rcp_f32 v42, v42
    v_rcp_f32 v43, v43
    s_add_u32 m0, s33, 16384
    s_add_u32 s7, s38, 98304
    buffer_load_dwordx4 v233, s[16:19], s7 offen lds
    s_add_u32 m0, s33, 17408
    s_add_u32 s7, s38, 106496
    buffer_load_dwordx4 v233, s[16:19], s7 offen lds
    s_waitcnt lgkmcnt(4)
    v_mfma_f32_16x16x32_bf16 v[200:203], v[152:155], v[20:23], v[200:203]
    v_rcp_f32 v44, v44
    v_rcp_f32 v45, v45
    v_rcp_f32 v46, v46
    v_mfma_f32_16x16x32_bf16 v[204:207], v[156:159], v[20:23], v[204:207]
    v_rcp_f32 v47, v47
    v_mul_f32 v208, v208, v40
    v_mul_f32 v209, v209, v41
    s_waitcnt lgkmcnt(3)
    v_mfma_f32_16x16x32_bf16 v[200:203], v[160:163], v[24:27], v[200:203]
    v_mul_f32 v210, v210, v42
    v_mul_f32 v211, v211, v43
    v_mul_f32 v212, v212, v44
    v_mfma_f32_16x16x32_bf16 v[204:207], v[164:167], v[24:27], v[204:207]
    v_mul_f32 v213, v213, v45
    v_mul_f32 v214, v214, v46
    v_mul_f32 v215, v215, v47
    s_add_u32 m0, s33, 20480
    s_add_u32 s7, s38, 131072
    buffer_load_dwordx4 v233, s[16:19], s7 offen lds
    s_add_u32 m0, s33, 21504
    s_add_u32 s7, s38, 139264
    buffer_load_dwordx4 v233, s[16:19], s7 offen lds
    s_waitcnt lgkmcnt(2)
    v_mfma_f32_16x16x32_bf16 v[200:203], v[168:171], v[28:31], v[200:203]
    v_cvt_pk_bf16_f32 v48, v208, v209
    v_cvt_pk_bf16_f32 v49, v210, v211
    v_cvt_pk_bf16_f32 v50, v212, v213
    v_mfma_f32_16x16x32_bf16 v[204:207], v[172:175], v[28:31], v[204:207]
    v_cvt_pk_bf16_f32 v51, v214, v215
    s_add_u32 s7, s50, 57344
    buffer_store_dwordx4 v[48:51], v232, s[28:31], s7 offen sc1
    s_waitcnt lgkmcnt(1)
    v_mfma_f32_16x16x32_bf16 v[200:203], v[176:179], v[32:35], v[200:203]
    v_mfma_f32_16x16x32_bf16 v[204:207], v[180:183], v[32:35], v[204:207]
    s_add_u32 s43, s43, 131072
    buffer_load_dword v3, v2, s[16:19], s43 offen
    s_waitcnt lgkmcnt(0)
    v_mfma_f32_16x16x32_bf16 v[200:203], v[184:187], v[36:39], v[200:203]
    v_mfma_f32_16x16x32_bf16 v[204:207], v[188:191], v[36:39], v[204:207]
    s_waitcnt vmcnt(8) lgkmcnt(0)
    s_barrier
    s_cmp_lg_u32 s6, 0
    s_cbranch_scc1 adaLN_cond__ssm_conv_h3__mixer_s_mlp__prompt_kernel_ow92
    s_cmp_eq_u32 s44, 0
    s_cbranch_scc1 adaLN_cond__ssm_conv_h3__mixer_s_mlp__prompt_kernel_gf93
    s_lshl_b32 s3, s4, 5
    s_add_u32 s3, s3, s5
    s_lshl_b32 s3, s3, 7
    s_add_u32 s3, s3, 4390912
    v_lshlrev_b32 v253, 3, v1
    s_mov_b64 s[46:47], exec
    s_mov_b64 exec, 0xffff
    buffer_store_dwordx2 v[248:249], v253, s[28:31], s3 offen sc1
    s_mov_b64 exec, s[46:47]
    s_mov_b32 s44, 0
adaLN_cond__ssm_conv_h3__mixer_s_mlp__prompt_kernel_gf93:
adaLN_cond__ssm_conv_h3__mixer_s_mlp__prompt_kernel_ow92:
    ds_read_b128 v[8:11], v58 offset:49152
    ds_read_b128 v[12:15], v58 offset:50176
    ds_read_b128 v[16:19], v58 offset:51200
    ds_read_b128 v[20:23], v58 offset:52224
    ds_read_b128 v[24:27], v58 offset:53248
    ds_read_b128 v[28:31], v58 offset:54272
    s_waitcnt lgkmcnt(5)
    v_mfma_f32_16x16x32_bf16 v[208:211], v[64:67], v[8:11], 0
    v_mfma_f32_16x16x32_bf16 v[212:215], v[68:71], v[8:11], 0
    ds_read_b128 v[32:35], v58 offset:55296
    s_add_u32 m0, s33, 32768
    s_add_u32 s7, s38, 163840
    buffer_load_dwordx4 v233, s[16:19], s7 offen lds
    s_add_u32 m0, s33, 33792
    s_add_u32 s7, s38, 172032
    buffer_load_dwordx4 v233, s[16:19], s7 offen lds
    s_waitcnt lgkmcnt(5)
    v_mfma_f32_16x16x32_bf16 v[208:211], v[72:75], v[12:15], v[208:211]
    v_mul_f32 v40, v192, v221
    v_mul_f32 v41, v193, v221
    v_mul_f32 v42, v194, v221
    v_mfma_f32_16x16x32_bf16 v[212:215], v[76:79], v[12:15], v[212:215]
    v_mul_f32 v43, v195, v221
    v_mul_f32 v44, v196, v221
    v_mul_f32 v45, v197, v221
    ds_read_b128 v[36:39], v58 offset:56320
    s_waitcnt lgkmcnt(5)
    v_mfma_f32_16x16x32_bf16 v[208:211], v[80:83], v[16:19], v[208:211]
    v_mul_f32 v46, v198, v221
    v_mul_f32 v47, v199, v221
    v_fma_f32 v200, v200, v220, v40
    v_mfma_f32_16x16x32_bf16 v[212:215], v[84:87], v[16:19], v[212:215]
    v_fma_f32 v201, v201, v220, v41
    v_fma_f32 v202, v202, v220, v42
    v_fma_f32 v203, v203, v220, v43
    ds_read_b128 v[8:11], v58 offset:57344
    s_waitcnt lgkmcnt(5)
    v_mfma_f32_16x16x32_bf16 v[208:211], v[88:91], v[20:23], v[208:211]
    v_fma_f32 v204, v204, v220, v44
    v_fma_f32 v205, v205, v220, v45
    v_fma_f32 v206, v206, v220, v46
    v_mfma_f32_16x16x32_bf16 v[212:215], v[92:95], v[20:23], v[212:215]
    v_fma_f32 v207, v207, v220, v47
    v_mul_f32 v40, v200, v200
    v_mul_f32 v41, v201, v201
    ds_read_b128 v[12:15], v58 offset:58368
    s_add_u32 m0, s33, 36864
    s_add_u32 s7, s38, 196608
    buffer_load_dwordx4 v233, s[16:19], s7 offen lds
    s_add_u32 m0, s33, 37888
    s_add_u32 s7, s38, 204800
    buffer_load_dwordx4 v233, s[16:19], s7 offen lds
    s_waitcnt lgkmcnt(5)
    v_mfma_f32_16x16x32_bf16 v[208:211], v[96:99], v[24:27], v[208:211]
    v_mul_f32 v42, v202, v202
    v_mul_f32 v43, v203, v203
    v_mul_f32 v44, v204, v204
    v_mfma_f32_16x16x32_bf16 v[212:215], v[100:103], v[24:27], v[212:215]
    v_mul_f32 v45, v205, v205
    v_mul_f32 v46, v206, v206
    v_mul_f32 v47, v207, v207
    ds_read_b128 v[16:19], v58 offset:59392
    s_waitcnt lgkmcnt(5)
    v_mfma_f32_16x16x32_bf16 v[208:211], v[104:107], v[28:31], v[208:211]
    v_fmaak_f32 v40, v40, v237, 0xc0135761
    v_fmaak_f32 v41, v41, v237, 0xc0135761
    v_fmaak_f32 v42, v42, v237, 0xc0135761
    v_mfma_f32_16x16x32_bf16 v[212:215], v[108:111], v[28:31], v[212:215]
    v_fmaak_f32 v43, v43, v237, 0xc0135761
    v_fmaak_f32 v44, v44, v237, 0xc0135761
    v_fmaak_f32 v45, v45, v237, 0xc0135761
    ds_read_b128 v[20:23], v58 offset:60416
    s_waitcnt lgkmcnt(5)
    v_mfma_f32_16x16x32_bf16 v[208:211], v[112:115], v[32:35], v[208:211]
    v_fmaak_f32 v46, v46, v237, 0xc0135761
    v_fmaak_f32 v47, v47, v237, 0xc0135761
    v_mul_f32 v40, v40, v200
    v_mfma_f32_16x16x32_bf16 v[212:215], v[116:119], v[32:35], v[212:215]
    v_mul_f32 v41, v41, v201
    v_mul_f32 v42, v42, v202
    v_mul_f32 v43, v43, v203
    ds_read_b128 v[24:27], v58 offset:61440
    s_waitcnt lgkmcnt(5)
    v_mfma_f32_16x16x32_bf16 v[208:211], v[120:123], v[36:39], v[208:211]
    v_mul_f32 v44, v44, v204
    v_mul_f32 v45, v45, v205
    v_mul_f32 v46, v46, v206
    v_mfma_f32_16x16x32_bf16 v[212:215], v[124:127], v[36:39], v[212:215]
    v_mul_f32 v47, v47, v207
    v_exp_f32 v40, v40
    v_exp_f32 v41, v41
    ds_read_b128 v[28:31], v58 offset:62464
    s_waitcnt lgkmcnt(5)
    v_mfma_f32_16x16x32_bf16 v[208:211], v[128:131], v[8:11], v[208:211]
    v_exp_f32 v42, v42
    v_exp_f32 v43, v43
    v_exp_f32 v44, v44
    v_mfma_f32_16x16x32_bf16 v[212:215], v[132:135], v[8:11], v[212:215]
    v_exp_f32 v45, v45
    v_exp_f32 v46, v46
    v_exp_f32 v47, v47
    ds_read_b128 v[32:35], v58 offset:63488
    s_waitcnt lgkmcnt(5)
    v_mfma_f32_16x16x32_bf16 v[208:211], v[136:139], v[12:15], v[208:211]
    v_add_f32 v40, 1.0, v40
    v_add_f32 v41, 1.0, v41
    v_add_f32 v42, 1.0, v42
    v_mfma_f32_16x16x32_bf16 v[212:215], v[140:143], v[12:15], v[212:215]
    v_add_f32 v43, 1.0, v43
    v_add_f32 v44, 1.0, v44
    v_add_f32 v45, 1.0, v45
    ds_read_b128 v[36:39], v58 offset:64512
    s_waitcnt lgkmcnt(5)
    v_mfma_f32_16x16x32_bf16 v[208:211], v[144:147], v[16:19], v[208:211]
    v_add_f32 v46, 1.0, v46
    v_add_f32 v47, 1.0, v47
    v_rcp_f32 v40, v40
    v_mfma_f32_16x16x32_bf16 v[212:215], v[148:151], v[16:19], v[212:215]
    v_rcp_f32 v41, v41
    v_rcp_f32 v42, v42
    v_rcp_f32 v43, v43
    s_waitcnt lgkmcnt(4)
    v_mfma_f32_16x16x32_bf16 v[208:211], v[152:155], v[20:23], v[208:211]
    v_rcp_f32 v44, v44
    v_rcp_f32 v45, v45
    v_rcp_f32 v46, v46
    v_mfma_f32_16x16x32_bf16 v[212:215], v[156:159], v[20:23], v[212:215]
    v_rcp_f32 v47, v47
    v_mul_f32 v200, v200, v40
    v_mul_f32 v201, v201, v41
    s_waitcnt lgkmcnt(3)
    v_mfma_f32_16x16x32_bf16 v[208:211], v[160:163], v[24:27], v[208:211]
    v_mul_f32 v202, v202, v42
    v_mul_f32 v203, v203, v43
    v_mul_f32 v204, v204, v44
    v_mfma_f32_16x16x32_bf16 v[212:215], v[164:167], v[24:27], v[212:215]
    v_mul_f32 v205, v205, v45
    v_mul_f32 v206, v206, v46
    v_mul_f32 v207, v207, v47
    s_waitcnt lgkmcnt(2)
    v_mfma_f32_16x16x32_bf16 v[208:211], v[168:171], v[28:31], v[208:211]
    v_cvt_pk_bf16_f32 v48, v200, v201
    v_cvt_pk_bf16_f32 v49, v202, v203
    v_cvt_pk_bf16_f32 v50, v204, v205
    v_mfma_f32_16x16x32_bf16 v[212:215], v[172:175], v[28:31], v[212:215]
    v_cvt_pk_bf16_f32 v51, v206, v207
    s_add_u32 s7, s50, 114688
    buffer_store_dwordx4 v[48:51], v232, s[28:31], s7 offen sc1
    s_waitcnt lgkmcnt(1)
    v_mfma_f32_16x16x32_bf16 v[208:211], v[176:179], v[32:35], v[208:211]
    v_mfma_f32_16x16x32_bf16 v[212:215], v[180:183], v[32:35], v[212:215]
    s_waitcnt lgkmcnt(0)
    v_mfma_f32_16x16x32_bf16 v[208:211], v[184:187], v[36:39], v[208:211]
    v_mfma_f32_16x16x32_bf16 v[212:215], v[188:191], v[36:39], v[212:215]
    s_waitcnt vmcnt(7)
    s_barrier
    v_mul_f32 v40, v192, v223
    v_mul_f32 v41, v193, v223
    v_mul_f32 v42, v194, v223
    v_mul_f32 v43, v195, v223
    s_add_u32 m0, s33, 49152
    s_add_u32 s7, s38, 229376
    buffer_load_dwordx4 v233, s[16:19], s7 offen lds
    s_add_u32 m0, s33, 50176
    s_add_u32 s7, s38, 237568
    buffer_load_dwordx4 v233, s[16:19], s7 offen lds
    v_mul_f32 v44, v196, v223
    v_mul_f32 v45, v197, v223
    v_mul_f32 v46, v198, v223
    v_mul_f32 v47, v199, v223
    v_fma_f32 v208, v208, v222, v40
    v_fma_f32 v209, v209, v222, v41
    v_fma_f32 v210, v210, v222, v42
    v_fma_f32 v211, v211, v222, v43
    v_fma_f32 v212, v212, v222, v44
    v_fma_f32 v213, v213, v222, v45
    v_fma_f32 v214, v214, v222, v46
    v_fma_f32 v215, v215, v222, v47
    v_mul_f32 v40, v208, v208
    v_mul_f32 v41, v209, v209
    v_mul_f32 v42, v210, v210
    v_mul_f32 v43, v211, v211
    v_mul_f32 v44, v212, v212
    v_mul_f32 v45, v213, v213
    v_mul_f32 v46, v214, v214
    v_mul_f32 v47, v215, v215
    v_fmaak_f32 v40, v40, v237, 0xc0135761
    v_fmaak_f32 v41, v41, v237, 0xc0135761
    v_fmaak_f32 v42, v42, v237, 0xc0135761
    v_fmaak_f32 v43, v43, v237, 0xc0135761
    v_fmaak_f32 v44, v44, v237, 0xc0135761
    v_fmaak_f32 v45, v45, v237, 0xc0135761
    s_add_u32 m0, s33, 53248
    s_add_u32 s7, s38, 262144
    buffer_load_dwordx4 v233, s[16:19], s7 offen lds
    s_add_u32 m0, s33, 54272
    s_add_u32 s7, s38, 270336
    buffer_load_dwordx4 v233, s[16:19], s7 offen lds
    v_fmaak_f32 v46, v46, v237, 0xc0135761
    v_fmaak_f32 v47, v47, v237, 0xc0135761
    v_mul_f32 v40, v40, v208
    v_mul_f32 v41, v41, v209
    v_mul_f32 v42, v42, v210
    v_mul_f32 v43, v43, v211
    v_mul_f32 v44, v44, v212
    v_mul_f32 v45, v45, v213
    v_mul_f32 v46, v46, v214
    v_mul_f32 v47, v47, v215
    v_exp_f32 v40, v40
    v_exp_f32 v41, v41
    v_exp_f32 v42, v42
    v_exp_f32 v43, v43
    v_exp_f32 v44, v44
    v_exp_f32 v45, v45
    v_exp_f32 v46, v46
    v_exp_f32 v47, v47
    v_add_f32 v40, 1.0, v40
    v_add_f32 v41, 1.0, v41
    v_add_f32 v42, 1.0, v42
    v_add_f32 v43, 1.0, v43
    v_add_f32 v44, 1.0, v44
    v_add_f32 v45, 1.0, v45
    v_add_f32 v46, 1.0, v46
    v_add_f32 v47, 1.0, v47
    v_rcp_f32 v40, v40
    v_rcp_f32 v41, v41
    v_rcp_f32 v42, v42
    v_rcp_f32 v43, v43
    v_rcp_f32 v44, v44
    v_rcp_f32 v45, v45
    v_rcp_f32 v46, v46
    v_rcp_f32 v47, v47
    v_mul_f32 v208, v208, v40
    v_mul_f32 v209, v209, v41
    v_mul_f32 v210, v210, v42
    v_mul_f32 v211, v211, v43
    v_mul_f32 v212, v212, v44
    v_mul_f32 v213, v213, v45
    v_mul_f32 v214, v214, v46
    v_mul_f32 v215, v215, v47
    v_cvt_pk_bf16_f32 v48, v208, v209
    v_cvt_pk_bf16_f32 v49, v210, v211
    v_cvt_pk_bf16_f32 v50, v212, v213
    v_cvt_pk_bf16_f32 v51, v214, v215
    s_add_u32 s7, s50, 172032
    buffer_store_dwordx4 v[48:51], v232, s[28:31], s7 offen sc1
    s_mov_b32 s45, 1
    s_branch adaLN_cond__ssm_conv_h3__mixer_s_mlp__prompt_kernel_g482
adaLN_cond__ssm_conv_h3__mixer_s_mlp__prompt_kernel_idle381:
    s_cmp_lg_u32 s6, 0
    s_cbranch_scc1 adaLN_cond__ssm_conv_h3__mixer_s_mlp__prompt_kernel_ow94
    s_cmp_eq_u32 s44, 0
    s_cbranch_scc1 adaLN_cond__ssm_conv_h3__mixer_s_mlp__prompt_kernel_gf95
    s_lshl_b32 s3, s4, 5
    s_add_u32 s3, s3, s5
    s_lshl_b32 s3, s3, 7
    s_add_u32 s3, s3, 4390912
    v_lshlrev_b32 v253, 3, v1
    s_mov_b64 s[46:47], exec
    s_mov_b64 exec, 0xffff
    buffer_store_dwordx2 v[248:249], v253, s[28:31], s3 offen sc1
    s_mov_b64 exec, s[46:47]
    s_mov_b32 s44, 0
adaLN_cond__ssm_conv_h3__mixer_s_mlp__prompt_kernel_gf95:
adaLN_cond__ssm_conv_h3__mixer_s_mlp__prompt_kernel_ow94:
    s_and_b32 s3, s5, 1
    s_lshr_b32 s7, s5, 4
    s_lshl_b32 s7, s7, 1
    s_add_u32 s3, s3, s7
    s_mul_i32 s3, s3, 458752
    s_add_u32 s3, s3, 360448
    s_add_u32 s8, s84, s3
    s_addc_u32 s9, s85, 0
    s_mov_b32 s10, 98304
    s_mov_b32 s11, 0x20000
    v_lshlrev_b32 v8, 7, v0
    s_waitcnt lgkmcnt(0)
    s_barrier
    s_add_u32 m0, s32, 0
    s_add_u32 s7, s38, 0
    buffer_load_dwordx4 v233, s[16:19], s7 offen lds
    s_add_u32 m0, s32, 1024
    s_add_u32 s7, s38, 8192
    buffer_load_dwordx4 v233, s[16:19], s7 offen lds
    s_add_u32 m0, s33, 0
    s_add_u32 s7, s38, 32768
    buffer_load_dwordx4 v233, s[16:19], s7 offen lds
    s_add_u32 m0, s33, 1024
    s_add_u32 s7, s38, 40960
    buffer_load_dwordx4 v233, s[16:19], s7 offen lds
    s_add_u32 m0, s33, 4096
    s_add_u32 s7, s38, 65536
    buffer_load_dwordx4 v233, s[16:19], s7 offen lds
    s_add_u32 m0, s33, 5120
    s_add_u32 s7, s38, 73728
    buffer_load_dwordx4 v233, s[16:19], s7 offen lds
    s_add_u32 m0, s33, 16384
    s_add_u32 s7, s38, 98304
    buffer_load_dwordx4 v233, s[16:19], s7 offen lds
    s_add_u32 m0, s33, 17408
    s_add_u32 s7, s38, 106496
    buffer_load_dwordx4 v233, s[16:19], s7 offen lds
    s_add_u32 m0, s33, 20480
    s_add_u32 s7, s38, 131072
    buffer_load_dwordx4 v233, s[16:19], s7 offen lds
    s_add_u32 m0, s33, 21504
    s_add_u32 s7, s38, 139264
    buffer_load_dwordx4 v233, s[16:19], s7 offen lds
    s_add_u32 m0, s33, 32768
    s_add_u32 s7, s38, 163840
    buffer_load_dwordx4 v233, s[16:19], s7 offen lds
    s_add_u32 m0, s33, 33792
    s_add_u32 s7, s38, 172032
    buffer_load_dwordx4 v233, s[16:19], s7 offen lds
    s_add_u32 m0, s33, 36864
    s_add_u32 s7, s38, 196608
    buffer_load_dwordx4 v233, s[16:19], s7 offen lds
    s_add_u32 m0, s33, 37888
    s_add_u32 s7, s38, 204800
    buffer_load_dwordx4 v233, s[16:19], s7 offen lds
    s_add_u32 m0, s33, 49152
    s_add_u32 s7, s38, 229376
    buffer_load_dwordx4 v233, s[16:19], s7 offen lds
    s_add_u32 m0, s33, 50176
    s_add_u32 s7, s38, 237568
    buffer_load_dwordx4 v233, s[16:19], s7 offen lds
    s_add_u32 m0, s33, 53248
    s_add_u32 s7, s38, 262144
    buffer_load_dwordx4 v233, s[16:19], s7 offen lds
    s_add_u32 m0, s33, 54272
    s_add_u32 s7, s38, 270336
    buffer_load_dwordx4 v233, s[16:19], s7 offen lds
    s_add_u32 s43, s43, 131072
    buffer_load_dword v3, v2, s[16:19], s43 offen
    s_mov_b32 s3, 0
    buffer_load_dword v9, v8, s[8:11], s3 offen
    s_mov_b32 s3, 65536
    buffer_load_dword v10, v8, s[8:11], s3 offen
    s_waitcnt vmcnt(0)
    s_barrier
    s_mov_b32 s45, 0
adaLN_cond__ssm_conv_h3__mixer_s_mlp__prompt_kernel_g482:
    s_mov_b32 s12, s90
    s_mov_b32 s13, s91
    s_mov_b32 s14, 2097152
    s_mov_b32 s15, 0x20000
    s_lshl_b32 s3, s25, 6
    s_lshl_b32 s35, s39, 12
    s_add_u32 s35, s35, 131072
    s_xor_b32 s7, s3, 0
    v_xor_b32 v56, s7, v235
    v_add_u32 v44, s35, v56
    v_add_u32 v56, s34, v56
    s_xor_b32 s7, s3, 32
    v_xor_b32 v57, s7, v235
    v_add_u32 v45, s35, v57
    v_add_u32 v57, s34, v57
    s_xor_b32 s7, s3, 64
    v_xor_b32 v58, s7, v235
    v_add_u32 v46, s35, v58
    v_add_u32 v58, s34, v58
    s_xor_b32 s7, s3, 96
    v_xor_b32 v59, s7, v235
    v_add_u32 v47, s35, v59
    v_add_u32 v59, s34, v59
    ds_read_b64_tr_b16 v[64:65], v44 offset:0
    ds_read_b64_tr_b16 v[66:67], v44 offset:2048
    ds_read_b64_tr_b16 v[68:69], v45 offset:0
    ds_read_b64_tr_b16 v[70:71], v45 offset:2048
    ds_read_b64_tr_b16 v[72:73], v46 offset:0
    ds_read_b64_tr_b16 v[74:75], v46 offset:2048
    ds_read_b64_tr_b16 v[76:77], v47 offset:0
    ds_read_b64_tr_b16 v[78:79], v47 offset:2048
    ds_read_b64_tr_b16 v[80:81], v56 offset:0
    ds_read_b64_tr_b16 v[82:83], v56 offset:2048
    ds_read_b64_tr_b16 v[84:85], v57 offset:0
    ds_read_b64_tr_b16 v[86:87], v57 offset:2048
    ds_read_b64_tr_b16 v[88:89], v58 offset:0
    ds_read_b64_tr_b16 v[90:91], v58 offset:2048
    s_waitcnt lgkmcnt(12)
    ds_read_b64_tr_b16 v[92:93], v59 offset:0
    ds_read_b64_tr_b16 v[94:95], v59 offset:2048
    s_waitcnt lgkmcnt(12)
    ds_read_b64_tr_b16 v[96:97], v56 offset:4096
    ds_read_b64_tr_b16 v[98:99], v56 offset:6144
    s_waitcnt lgkmcnt(12)
    ds_read_b64_tr_b16 v[100:101], v57 offset:4096
    ds_read_b64_tr_b16 v[102:103], v57 offset:6144
    s_waitcnt lgkmcnt(12)
    ds_read_b64_tr_b16 v[104:105], v58 offset:4096
    ds_read_b64_tr_b16 v[106:107], v58 offset:6144
    s_waitcnt lgkmcnt(12)
    ds_read_b64_tr_b16 v[108:109], v59 offset:4096
    ds_read_b64_tr_b16 v[110:111], v59 offset:6144
    s_waitcnt lgkmcnt(12)
    ds_read_b64_tr_b16 v[112:113], v56 offset:16384
    ds_read_b64_tr_b16 v[114:115], v56 offset:18432
    s_waitcnt lgkmcnt(12)
    ds_read_b64_tr_b16 v[116:117], v57 offset:16384
    ds_read_b64_tr_b16 v[118:119], v57 offset:18432
    s_waitcnt lgkmcnt(12)
    ds_read_b64_tr_b16 v[120:121], v58 offset:16384
    ds_read_b64_tr_b16 v[122:123], v58 offset:18432
    s_waitcnt lgkmcnt(12)
    ds_read_b64_tr_b16 v[124:125], v59 offset:16384
    ds_read_b64_tr_b16 v[126:127], v59 offset:18432
    s_waitcnt lgkmcnt(12)
    ds_read_b64_tr_b16 v[128:129], v56 offset:20480
    ds_read_b64_tr_b16 v[130:131], v56 offset:22528
    s_waitcnt lgkmcnt(12)
    ds_read_b64_tr_b16 v[132:133], v57 offset:20480
    ds_read_b64_tr_b16 v[134:135], v57 offset:22528
    s_waitcnt lgkmcnt(12)
    ds_read_b64_tr_b16 v[136:137], v58 offset:20480
    ds_read_b64_tr_b16 v[138:139], v58 offset:22528
    s_waitcnt lgkmcnt(12)
    ds_read_b64_tr_b16 v[140:141], v59 offset:20480
    ds_read_b64_tr_b16 v[142:143], v59 offset:22528
    s_add_u32 s58, s58, 8192
    s_add_u32 s59, s59, 8192
    s_mul_i32 s20, s27, 56
    s_mul_i32 s3, s39, 14
    s_add_u32 s20, s20, s3
    s_lshl_b32 s20, s20, 10
    s_add_u32 s20, s20, 14680064
    s_xor_b32 s21, s27, 1
    s_mul_i32 s21, s21, 56
    s_add_u32 s21, s21, s3
    s_lshl_b32 s21, s21, 10
    s_add_u32 s21, s21, 14680064
    s_waitcnt vmcnt(0) lgkmcnt(0)
    s_barrier
    s_cmp_lg_u32 s6, 0
    s_cbranch_scc1 adaLN_cond__ssm_conv_h3__mixer_s_mlp__prompt_kernel_ow97
    s_cmp_eq_u32 s45, 0
    s_cbranch_scc1 adaLN_cond__ssm_conv_h3__mixer_s_mlp__prompt_kernel_ns98
    v_mov_b32 v252, s59
    s_mov_b64 s[46:47], exec
    s_mov_b64 exec, 1
    buffer_store_dwordx2 v[248:249], v252, s[28:31], 0 offen
    s_mov_b64 exec, s[46:47]
    s_mov_b32 s44, 1
adaLN_cond__ssm_conv_h3__mixer_s_mlp__prompt_kernel_ns98:
adaLN_cond__ssm_conv_h3__mixer_s_mlp__prompt_kernel_ow97:
    ds_read_b64_tr_b16 v[144:145], v56 offset:32768
    ds_read_b64_tr_b16 v[146:147], v56 offset:34816
    ds_read_b64_tr_b16 v[148:149], v57 offset:32768
    ds_read_b64_tr_b16 v[150:151], v57 offset:34816
    ds_read_b64_tr_b16 v[152:153], v58 offset:32768
    ds_read_b64_tr_b16 v[154:155], v58 offset:34816
    ds_read_b64_tr_b16 v[156:157], v59 offset:32768
    ds_read_b64_tr_b16 v[158:159], v59 offset:34816
    ds_read_b64_tr_b16 v[160:161], v56 offset:36864
    ds_read_b64_tr_b16 v[162:163], v56 offset:38912
    ds_read_b64_tr_b16 v[164:165], v57 offset:36864
    ds_read_b64_tr_b16 v[166:167], v57 offset:38912
    ds_read_b64_tr_b16 v[168:169], v58 offset:36864
    ds_read_b64_tr_b16 v[170:171], v58 offset:38912
    s_waitcnt lgkmcnt(12)
    ds_read_b64_tr_b16 v[172:173], v59 offset:36864
    ds_read_b64_tr_b16 v[174:175], v59 offset:38912
    s_add_u32 m0, s32, 0
    s_add_u32 s7, s38, 294912
    buffer_load_dwordx4 v233, s[16:19], s7 offen lds
    s_add_u32 m0, s32, 1024
    s_add_u32 s7, s38, 303104
    buffer_load_dwordx4 v233, s[16:19], s7 offen lds
    s_add_u32 m0, s33, 0
    s_add_u32 s7, s38, 327680
    buffer_load_dwordx4 v233, s[16:19], s7 offen lds
    s_add_u32 m0, s33, 1024
    s_add_u32 s7, s38, 335872
    buffer_load_dwordx4 v233, s[16:19], s7 offen lds
    s_cmp_lg_u32 s6, 0
    s_cbranch_scc1 adaLN_cond__ssm_conv_h3__mixer_s_mlp__prompt_kernel_ow99
    v_min_u32 v252, 13, v1
    v_lshlrev_b32 v252, 3, v252
    s_mov_b32 s45, 0
adaLN_cond__ssm_conv_h3__mixer_s_mlp__prompt_kernel_pl100:
    buffer_load_dwordx2 v[250:251], v252, s[28:31], s58 offen sc1
    s_waitcnt vmcnt(0)
    v_cmp_ne_u64 vcc, v[248:249], v[250:251]
    s_cbranch_vccz adaLN_cond__ssm_conv_h3__mixer_s_mlp__prompt_kernel_ple101
    s_add_u32 s45, s45, 1
    s_cmp_lt_u32 s45, 48
    s_cbranch_scc1 adaLN_cond__ssm_conv_h3__mixer_s_mlp__prompt_kernel_pl100
    s_mov_b64 s[40:41], vcc
    s_cmp_eq_u32 s44, 0
    s_cbranch_scc1 adaLN_cond__ssm_conv_h3__mixer_s_mlp__prompt_kernel_gf103
    s_lshl_b32 s3, s4, 5
    s_add_u32 s3, s3, s5
    s_lshl_b32 s3, s3, 7
    s_add_u32 s3, s3, 4423680
    v_lshlrev_b32 v253, 3, v1
    s_mov_b64 s[46:47], exec
    s_mov_b64 exec, 0xffff
    buffer_store_dwordx2 v[248:249], v253, s[28:31], s3 offen sc1
    s_mov_b64 exec, s[46:47]
    s_mov_b32 s44, 0
adaLN_cond__ssm_conv_h3__mixer_s_mlp__prompt_kernel_gf103:
    s_lshl_b32 s3, s4, 5
    s_add_u32 s3, s3, s24
    s_lshl_b32 s3, s3, 7
    s_add_u32 s3, s3, 4423680
    v_lshlrev_b32 v253, 4, v252
    buffer_load_dwordx2 v[250:251], v253, s[28:31], s3 offen sc1
    s_waitcnt vmcnt(0)
    v_cmp_ne_u64 vcc, v[248:249], v[250:251]
    s_nop 0
    s_and_b64 vcc, vcc, s[40:41]
    s_cbranch_vccz adaLN_cond__ssm_conv_h3__mixer_s_mlp__prompt_kernel_ple101
    s_cmp_lt_u32 s45, 2000000
    s_cbranch_scc1 adaLN_cond__ssm_conv_h3__mixer_s_mlp__prompt_kernel_pl100
adaLN_cond__ssm_conv_h3__mixer_s_mlp__prompt_kernel_ple101:
adaLN_cond__ssm_conv_h3__mixer_s_mlp__prompt_kernel_ow99:
    s_waitcnt lgkmcnt(0)
    s_barrier
    s_add_u32 s7, s20, 0
    buffer_load_dwordx4 v[8:11], v232, s[28:31], s7 offen offset:0 sc1
    s_add_u32 s7, s21, 0
    buffer_load_dwordx4 v[12:15], v232, s[28:31], s7 offen offset:0 sc1
    s_barrier
    s_add_u32 s7, s20, 0
    buffer_load_dwordx4 v[16:19], v232, s[28:31], s7 offen offset:1024 sc1
    s_add_u32 s7, s21, 0
    buffer_load_dwordx4 v[20:23], v232, s[28:31], s7 offen offset:1024 sc1
    s_add_u32 s7, s20, 0
    buffer_load_dwordx4 v[24:27], v232, s[28:31], s7 offen offset:2048 sc1
    s_add_u32 s7, s21, 0
    buffer_load_dwordx4 v[28:31], v232, s[28:31], s7 offen offset:2048 sc1
    s_add_u32 s7, s20, 0
    buffer_load_dwordx4 v[32:35], v232, s[28:31], s7 offen offset:3072 sc1
    s_add_u32 s7, s21, 0
    buffer_load_dwordx4 v[36:39], v232, s[28:31], s7 offen offset:3072 sc1
    s_waitcnt vmcnt(6)
    v_mfma_f32_16x16x32_bf16 v[40:43], v[64:67], v[8:11], 0
    v_mfma_f32_16x16x32_bf16 v[176:179], v[64:67], v[12:15], 0
    s_add_u32 s7, s20, 4096
    buffer_load_dwordx4 v[192:195], v232, s[28:31], s7 offen offset:0 sc1
    v_mfma_f32_16x16x32_bf16 v[224:227], v[68:71], v[8:11], 0
    v_mfma_f32_16x16x32_bf16 v[180:183], v[68:71], v[12:15], 0
    s_add_u32 s7, s21, 4096
    buffer_load_dwordx4 v[196:199], v232, s[28:31], s7 offen offset:0 sc1
    v_mfma_f32_16x16x32_bf16 v[236:239], v[72:75], v[8:11], 0
    v_mfma_f32_16x16x32_bf16 v[184:187], v[72:75], v[12:15], 0
    v_mfma_f32_16x16x32_bf16 v[4:7], v[76:79], v[8:11], 0
    v_mfma_f32_16x16x32_bf16 v[188:191], v[76:79], v[12:15], 0
    s_waitcnt vmcnt(6)
    v_mfma_f32_16x16x32_bf16 v[40:43], v[80:83], v[16:19], v[40:43]
    v_mfma_f32_16x16x32_bf16 v[176:179], v[80:83], v[20:23], v[176:179]
    s_add_u32 s7, s20, 4096
    buffer_load_dwordx4 v[200:203], v232, s[28:31], s7 offen offset:1024 sc1
    v_mfma_f32_16x16x32_bf16 v[224:227], v[84:87], v[16:19], v[224:227]
    v_mfma_f32_16x16x32_bf16 v[180:183], v[84:87], v[20:23], v[180:183]
    s_add_u32 s7, s21, 4096
    buffer_load_dwordx4 v[204:207], v232, s[28:31], s7 offen offset:1024 sc1
    v_mfma_f32_16x16x32_bf16 v[236:239], v[88:91], v[16:19], v[236:239]
    v_mfma_f32_16x16x32_bf16 v[184:187], v[88:91], v[20:23], v[184:187]
    v_mfma_f32_16x16x32_bf16 v[4:7], v[92:95], v[16:19], v[4:7]
    v_mfma_f32_16x16x32_bf16 v[188:191], v[92:95], v[20:23], v[188:191]
    s_waitcnt vmcnt(6)
    v_mfma_f32_16x16x32_bf16 v[40:43], v[96:99], v[24:27], v[40:43]
    v_mfma_f32_16x16x32_bf16 v[176:179], v[96:99], v[28:31], v[176:179]
    s_add_u32 s7, s20, 4096
    buffer_load_dwordx4 v[208:211], v232, s[28:31], s7 offen offset:2048 sc1
    v_mfma_f32_16x16x32_bf16 v[224:227], v[100:103], v[24:27], v[224:227]
    v_mfma_f32_16x16x32_bf16 v[180:183], v[100:103], v[28:31], v[180:183]
    s_add_u32 s7, s21, 4096
    buffer_load_dwordx4 v[212:215], v232, s[28:31], s7 offen offset:2048 sc1
    v_mfma_f32_16x16x32_bf16 v[236:239], v[104:107], v[24:27], v[236:239]
    v_mfma_f32_16x16x32_bf16 v[184:187], v[104:107], v[28:31], v[184:187]
    v_mfma_f32_16x16x32_bf16 v[4:7], v[108:111], v[24:27], v[4:7]
    v_mfma_f32_16x16x32_bf16 v[188:191], v[108:111], v[28:31], v[188:191]
    s_waitcnt vmcnt(6)
    v_mfma_f32_16x16x32_bf16 v[40:43], v[112:115], v[32:35], v[40:43]
    v_mfma_f32_16x16x32_bf16 v[176:179], v[112:115], v[36:39], v[176:179]
    s_add_u32 s7, s20, 4096
    buffer_load_dwordx4 v[216:219], v232, s[28:31], s7 offen offset:3072 sc1
    v_mfma_f32_16x16x32_bf16 v[224:227], v[116:119], v[32:35], v[224:227]
    v_mfma_f32_16x16x32_bf16 v[180:183], v[116:119], v[36:39], v[180:183]
    s_add_u32 s7, s21, 4096
    buffer_load_dwordx4 v[220:223], v232, s[28:31], s7 offen offset:3072 sc1
    v_mfma_f32_16x16x32_bf16 v[236:239], v[120:123], v[32:35], v[236:239]
    v_mfma_f32_16x16x32_bf16 v[184:187], v[120:123], v[36:39], v[184:187]
    s_add_u32 m0, s33, 4096
    s_add_u32 s7, s38, 360448
    buffer_load_dwordx4 v233, s[16:19], s7 offen lds
    s_add_u32 m0, s33, 5120
    s_add_u32 s7, s38, 368640
    buffer_load_dwordx4 v233, s[16:19], s7 offen lds
    v_mfma_f32_16x16x32_bf16 v[4:7], v[124:127], v[32:35], v[4:7]
    v_mfma_f32_16x16x32_bf16 v[188:191], v[124:127], v[36:39], v[188:191]
    s_waitcnt vmcnt(8)
    v_mfma_f32_16x16x32_bf16 v[40:43], v[128:131], v[192:195], v[40:43]
    v_mfma_f32_16x16x32_bf16 v[176:179], v[128:131], v[196:199], v[176:179]
    s_add_u32 s7, s20, 8192
    buffer_load_dwordx4 v[8:11], v232, s[28:31], s7 offen offset:0 sc1
    v_mfma_f32_16x16x32_bf16 v[224:227], v[132:135], v[192:195], v[224:227]
    v_mfma_f32_16x16x32_bf16 v[180:183], v[132:135], v[196:199], v[180:183]
    s_add_u32 s7, s21, 8192
    buffer_load_dwordx4 v[12:15], v232, s[28:31], s7 offen offset:0 sc1
    v_mfma_f32_16x16x32_bf16 v[236:239], v[136:139], v[192:195], v[236:239]
    v_mfma_f32_16x16x32_bf16 v[184:187], v[136:139], v[196:199], v[184:187]
    s_add_u32 m0, s33, 16384
    s_add_u32 s7, s38, 393216
    buffer_load_dwordx4 v233, s[16:19], s7 offen lds
    s_add_u32 m0, s33, 17408
    s_add_u32 s7, s38, 401408
    buffer_load_dwordx4 v233, s[16:19], s7 offen lds
    v_mfma_f32_16x16x32_bf16 v[4:7], v[140:143], v[192:195], v[4:7]
    v_mfma_f32_16x16x32_bf16 v[188:191], v[140:143], v[196:199], v[188:191]
    s_waitcnt vmcnt(10)
    v_mfma_f32_16x16x32_bf16 v[40:43], v[144:147], v[200:203], v[40:43]
    v_mfma_f32_16x16x32_bf16 v[176:179], v[144:147], v[204:207], v[176:179]
    s_add_u32 s7, s20, 8192
    buffer_load_dwordx4 v[16:19], v232, s[28:31], s7 offen offset:1024 sc1
    v_mfma_f32_16x16x32_bf16 v[224:227], v[148:151], v[200:203], v[224:227]
    v_mfma_f32_16x16x32_bf16 v[180:183], v[148:151], v[204:207], v[180:183]
    s_add_u32 s7, s21, 8192
    buffer_load_dwordx4 v[20:23], v232, s[28:31], s7 offen offset:1024 sc1
    v_mfma_f32_16x16x32_bf16 v[236:239], v[152:155], v[200:203], v[236:239]
    v_mfma_f32_16x16x32_bf16 v[184:187], v[152:155], v[204:207], v[184:187]
    s_add_u32 m0, s33, 20480
    s_add_u32 s7, s38, 425984
    buffer_load_dwordx4 v233, s[16:19], s7 offen lds
    s_add_u32 m0, s33, 21504
    s_add_u32 s7, s38, 434176
    buffer_load_dwordx4 v233, s[16:19], s7 offen lds
    v_mfma_f32_16x16x32_bf16 v[4:7], v[156:159], v[200:203], v[4:7]
    v_mfma_f32_16x16x32_bf16 v[188:191], v[156:159], v[204:207], v[188:191]
    s_waitcnt vmcnt(12)
    v_mfma_f32_16x16x32_bf16 v[40:43], v[160:163], v[208:211], v[40:43]
    v_mfma_f32_16x16x32_bf16 v[176:179], v[160:163], v[212:215], v[176:179]
    ds_read_b64_tr_b16 v[80:81], v56 offset:49152
    ds_read_b64_tr_b16 v[82:83], v56 offset:51200
    s_add_u32 s7, s20, 8192
    buffer_load_dwordx4 v[24:27], v232, s[28:31], s7 offen offset:2048 sc1
    v_mfma_f32_16x16x32_bf16 v[224:227], v[164:167], v[208:211], v[224:227]
    v_mfma_f32_16x16x32_bf16 v[180:183], v[164:167], v[212:215], v[180:183]
    ds_read_b64_tr_b16 v[84:85], v57 offset:49152
    ds_read_b64_tr_b16 v[86:87], v57 offset:51200
    s_add_u32 s7, s21, 8192
    buffer_load_dwordx4 v[28:31], v232, s[28:31], s7 offen offset:2048 sc1
    v_mfma_f32_16x16x32_bf16 v[236:239], v[168:171], v[208:211], v[236:239]
    v_mfma_f32_16x16x32_bf16 v[184:187], v[168:171], v[212:215], v[184:187]
    ds_read_b64_tr_b16 v[88:89], v58 offset:49152
    ds_read_b64_tr_b16 v[90:91], v58 offset:51200
    v_mfma_f32_16x16x32_bf16 v[4:7], v[172:175], v[208:211], v[4:7]
    v_mfma_f32_16x16x32_bf16 v[188:191], v[172:175], v[212:215], v[188:191]
    ds_read_b64_tr_b16 v[92:93], v59 offset:49152
    ds_read_b64_tr_b16 v[94:95], v59 offset:51200
    s_waitcnt vmcnt(12)
    s_waitcnt lgkmcnt(6)
    v_mfma_f32_16x16x32_bf16 v[40:43], v[80:83], v[216:219], v[40:43]
    v_mfma_f32_16x16x32_bf16 v[176:179], v[80:83], v[220:223], v[176:179]
    ds_read_b64_tr_b16 v[64:65], v56 offset:53248
    ds_read_b64_tr_b16 v[66:67], v56 offset:55296
    s_add_u32 s7, s20, 8192
    buffer_load_dwordx4 v[32:35], v232, s[28:31], s7 offen offset:3072 sc1
    s_waitcnt lgkmcnt(6)
    v_mfma_f32_16x16x32_bf16 v[224:227], v[84:87], v[216:219], v[224:227]
    v_mfma_f32_16x16x32_bf16 v[180:183], v[84:87], v[220:223], v[180:183]
    ds_read_b64_tr_b16 v[68:69], v57 offset:53248
    ds_read_b64_tr_b16 v[70:71], v57 offset:55296
    s_add_u32 s7, s21, 8192
    buffer_load_dwordx4 v[36:39], v232, s[28:31], s7 offen offset:3072 sc1
    s_waitcnt lgkmcnt(6)
    v_mfma_f32_16x16x32_bf16 v[236:239], v[88:91], v[216:219], v[236:239]
    v_mfma_f32_16x16x32_bf16 v[184:187], v[88:91], v[220:223], v[184:187]
    ds_read_b64_tr_b16 v[72:73], v58 offset:53248
    ds_read_b64_tr_b16 v[74:75], v58 offset:55296
    s_waitcnt lgkmcnt(6)
    v_mfma_f32_16x16x32_bf16 v[4:7], v[92:95], v[216:219], v[4:7]
    v_mfma_f32_16x16x32_bf16 v[188:191], v[92:95], v[220:223], v[188:191]
    ds_read_b64_tr_b16 v[76:77], v59 offset:53248
    ds_read_b64_tr_b16 v[78:79], v59 offset:55296
    s_waitcnt vmcnt(10)
    s_waitcnt lgkmcnt(6)
    v_mfma_f32_16x16x32_bf16 v[40:43], v[64:67], v[8:11], v[40:43]
    v_mfma_f32_16x16x32_bf16 v[176:179], v[64:67], v[12:15], v[176:179]
    s_waitcnt vmcnt(12)
    s_barrier
    ds_read_b64_tr_b16 v[80:81], v44 offset:0
    ds_read_b64_tr_b16 v[82:83], v44 offset:2048
    s_add_u32 s7, s20, 12288
    buffer_load_dwordx4 v[192:195], v232, s[28:31], s7 offen offset:0 sc1
    s_waitcnt lgkmcnt(6)
    v_mfma_f32_16x16x32_bf16 v[224:227], v[68:71], v[8:11], v[224:227]
    v_mfma_f32_16x16x32_bf16 v[180:183], v[68:71], v[12:15], v[180:183]
    ds_read_b64_tr_b16 v[84:85], v45 offset:0
    ds_read_b64_tr_b16 v[86:87], v45 offset:2048
    s_add_u32 s7, s21, 12288
    buffer_load_dwordx4 v[196:199], v232, s[28:31], s7 offen offset:0 sc1
    s_waitcnt lgkmcnt(6)
    v_mfma_f32_16x16x32_bf16 v[236:239], v[72:75], v[8:11], v[236:239]
    v_mfma_f32_16x16x32_bf16 v[184:187], v[72:75], v[12:15], v[184:187]
    ds_read_b64_tr_b16 v[88:89], v46 offset:0
    ds_read_b64_tr_b16 v[90:91], v46 offset:2048
    s_waitcnt lgkmcnt(6)
    v_mfma_f32_16x16x32_bf16 v[4:7], v[76:79], v[8:11], v[4:7]
    v_mfma_f32_16x16x32_bf16 v[188:191], v[76:79], v[12:15], v[188:191]
    ds_read_b64_tr_b16 v[92:93], v47 offset:0
    ds_read_b64_tr_b16 v[94:95], v47 offset:2048
    s_waitcnt vmcnt(8)
    s_waitcnt lgkmcnt(6)
    v_mfma_f32_16x16x32_bf16 v[40:43], v[80:83], v[16:19], v[40:43]
    v_mfma_f32_16x16x32_bf16 v[176:179], v[80:83], v[20:23], v[176:179]
    ds_read_b64_tr_b16 v[64:65], v56 offset:0
    ds_read_b64_tr_b16 v[66:67], v56 offset:2048
    s_add_u32 s7, s20, 12288
    buffer_load_dwordx4 v[200:203], v232, s[28:31], s7 offen offset:1024 sc1
    s_waitcnt lgkmcnt(6)
    v_mfma_f32_16x16x32_bf16 v[224:227], v[84:87], v[16:19], v[224:227]
    v_mfma_f32_16x16x32_bf16 v[180:183], v[84:87], v[20:23], v[180:183]
    ds_read_b64_tr_b16 v[68:69], v57 offset:0
    ds_read_b64_tr_b16 v[70:71], v57 offset:2048
    s_add_u32 s7, s21, 12288
    buffer_load_dwordx4 v[204:207], v232, s[28:31], s7 offen offset:1024 sc1
    s_waitcnt lgkmcnt(6)
    v_mfma_f32_16x16x32_bf16 v[236:239], v[88:91], v[16:19], v[236:239]
    v_mfma_f32_16x16x32_bf16 v[184:187], v[88:91], v[20:23], v[184:187]
    ds_read_b64_tr_b16 v[72:73], v58 offset:0
    ds_read_b64_tr_b16 v[74:75], v58 offset:2048
    s_waitcnt lgkmcnt(6)
    v_mfma_f32_16x16x32_bf16 v[4:7], v[92:95], v[16:19], v[4:7]
    v_mfma_f32_16x16x32_bf16 v[188:191], v[92:95], v[20:23], v[188:191]
    ds_read_b64_tr_b16 v[76:77], v59 offset:0
    ds_read_b64_tr_b16 v[78:79], v59 offset:2048
    s_waitcnt vmcnt(6)
    s_waitcnt lgkmcnt(6)
    v_mfma_f32_16x16x32_bf16 v[40:43], v[64:67], v[24:27], v[40:43]
    v_mfma_f32_16x16x32_bf16 v[176:179], v[64:67], v[28:31], v[176:179]
    ds_read_b64_tr_b16 v[80:81], v56 offset:4096
    ds_read_b64_tr_b16 v[82:83], v56 offset:6144
    s_waitcnt lgkmcnt(6)
    v_mfma_f32_16x16x32_bf16 v[224:227], v[68:71], v[24:27], v[224:227]
    v_mfma_f32_16x16x32_bf16 v[180:183], v[68:71], v[28:31], v[180:183]
    ds_read_b64_tr_b16 v[84:85], v57 offset:4096
    ds_read_b64_tr_b16 v[86:87], v57 offset:6144
    s_waitcnt lgkmcnt(6)
    v_mfma_f32_16x16x32_bf16 v[236:239], v[72:75], v[24:27], v[236:239]
    v_mfma_f32_16x16x32_bf16 v[184:187], v[72:75], v[28:31], v[184:187]
    ds_read_b64_tr_b16 v[88:89], v58 offset:4096
    ds_read_b64_tr_b16 v[90:91], v58 offset:6144
    s_waitcnt lgkmcnt(6)
    v_mfma_f32_16x16x32_bf16 v[4:7], v[76:79], v[24:27], v[4:7]
    v_mfma_f32_16x16x32_bf16 v[188:191], v[76:79], v[28:31], v[188:191]
    ds_read_b64_tr_b16 v[92:93], v59 offset:4096
    ds_read_b64_tr_b16 v[94:95], v59 offset:6144
    s_waitcnt vmcnt(4)
    s_waitcnt lgkmcnt(6)
    v_mfma_f32_16x16x32_bf16 v[40:43], v[80:83], v[32:35], v[40:43]
    v_mfma_f32_16x16x32_bf16 v[176:179], v[80:83], v[36:39], v[176:179]
    s_waitcnt vmcnt(8)
    s_barrier
    ds_read_b64_tr_b16 v[64:65], v56 offset:16384
    ds_read_b64_tr_b16 v[66:67], v56 offset:18432
    s_waitcnt lgkmcnt(6)
    v_mfma_f32_16x16x32_bf16 v[224:227], v[84:87], v[32:35], v[224:227]
    v_mfma_f32_16x16x32_bf16 v[180:183], v[84:87], v[36:39], v[180:183]
    ds_read_b64_tr_b16 v[68:69], v57 offset:16384
    ds_read_b64_tr_b16 v[70:71], v57 offset:18432
    s_waitcnt lgkmcnt(6)
    v_mfma_f32_16x16x32_bf16 v[236:239], v[88:91], v[32:35], v[236:239]
    v_mfma_f32_16x16x32_bf16 v[184:187], v[88:91], v[36:39], v[184:187]
    ds_read_b64_tr_b16 v[72:73], v58 offset:16384
    ds_read_b64_tr_b16 v[74:75], v58 offset:18432
    s_add_u32 s7, s49, 5187584
    buffer_load_dwordx4 v[128:131], v62, s[28:31], s7 offen sc1
    buffer_load_dwordx4 v[132:135], v62, s[28:31], s7 offen offset:64 sc1
    s_waitcnt lgkmcnt(6)
    v_mfma_f32_16x16x32_bf16 v[4:7], v[92:95], v[32:35], v[4:7]
    v_mfma_f32_16x16x32_bf16 v[188:191], v[92:95], v[36:39], v[188:191]
    ds_read_b64_tr_b16 v[76:77], v59 offset:16384
    ds_read_b64_tr_b16 v[78:79], v59 offset:18432
    s_waitcnt vmcnt(4)
    s_waitcnt lgkmcnt(6)
    v_mfma_f32_16x16x32_bf16 v[40:43], v[64:67], v[192:195], v[40:43]
    v_mfma_f32_16x16x32_bf16 v[176:179], v[64:67], v[196:199], v[176:179]
    ds_read_b64_tr_b16 v[80:81], v56 offset:20480
    ds_read_b64_tr_b16 v[82:83], v56 offset:22528
    s_waitcnt lgkmcnt(6)
    v_mfma_f32_16x16x32_bf16 v[224:227], v[68:71], v[192:195], v[224:227]
    v_mfma_f32_16x16x32_bf16 v[180:183], v[68:71], v[196:199], v[180:183]
    ds_read_b64_tr_b16 v[84:85], v57 offset:20480
    ds_read_b64_tr_b16 v[86:87], v57 offset:22528
    s_waitcnt lgkmcnt(6)
    v_mfma_f32_16x16x32_bf16 v[236:239], v[72:75], v[192:195], v[236:239]
    v_mfma_f32_16x16x32_bf16 v[184:187], v[72:75], v[196:199], v[184:187]
    ds_read_b64_tr_b16 v[88:89], v58 offset:20480
    ds_read_b64_tr_b16 v[90:91], v58 offset:22528
    s_waitcnt lgkmcnt(6)
    v_mfma_f32_16x16x32_bf16 v[4:7], v[76:79], v[192:195], v[4:7]
    v_mfma_f32_16x16x32_bf16 v[188:191], v[76:79], v[196:199], v[188:191]
    ds_read_b64_tr_b16 v[92:93], v59 offset:20480
    ds_read_b64_tr_b16 v[94:95], v59 offset:22528
    s_waitcnt vmcnt(2)
    s_waitcnt lgkmcnt(6)
    v_mfma_f32_16x16x32_bf16 v[40:43], v[80:83], v[200:203], v[40:43]
    v_mfma_f32_16x16x32_bf16 v[176:179], v[80:83], v[204:207], v[176:179]
    s_waitcnt lgkmcnt(4)
    v_mfma_f32_16x16x32_bf16 v[224:227], v[84:87], v[200:203], v[224:227]
    v_mfma_f32_16x16x32_bf16 v[180:183], v[84:87], v[204:207], v[180:183]
    s_waitcnt lgkmcnt(2)
    v_mfma_f32_16x16x32_bf16 v[236:239], v[88:91], v[200:203], v[236:239]
    v_mfma_f32_16x16x32_bf16 v[184:187], v[88:91], v[204:207], v[184:187]
    s_waitcnt lgkmcnt(0)
    v_mfma_f32_16x16x32_bf16 v[4:7], v[92:95], v[200:203], v[4:7]
    v_mfma_f32_16x16x32_bf16 v[188:191], v[92:95], v[204:207], v[188:191]
    v_and_b32 v2, 15, v1
    v_lshlrev_b32 v2, 10, v2
    v_lshrrev_b32 v3, 4, v1
    v_lshl_add_u32 v2, v3, 3, v2
    s_lshl_b32 s20, s27, 14
    s_lshl_b32 s7, s55, 7
    s_add_u32 s20, s20, s7
    s_lshl_b32 s7, s25, 6
    s_add_u32 s20, s20, s7
    s_mul_i32 s3, s6, 6144
    v_add_u32 v48, s3, v232
    s_xor_b32 s3, s6, 4
    s_mul_i32 s3, s3, 6144
    v_add_u32 v49, s3, v232
    s_xor_b32 s3, s6, 1
    s_mul_i32 s3, s3, 6144
    v_add_u32 v50, s3, v232
    s_xor_b32 s3, s6, 5
    s_mul_i32 s3, s3, 6144
    v_add_u32 v51, s3, v232
    s_barrier
    ds_write_b128 v48, v[236:239]
    ds_write_b128 v48, v[4:7] offset:1024
    ds_write_b128 v48, v[176:179] offset:2048
    ds_write_b128 v48, v[180:183] offset:3072
    ds_write_b128 v48, v[184:187] offset:4096
    ds_write_b128 v48, v[188:191] offset:5120
    v_lshlrev_b32 v8, 16, v244
    v_and_b32 v9, 0xffff0000, v244
    v_lshlrev_b32 v10, 16, v245
    v_and_b32 v11, 0xffff0000, v245
    v_lshlrev_b32 v12, 16, v246
    v_and_b32 v13, 0xffff0000, v246
    v_lshlrev_b32 v14, 16, v247
    v_and_b32 v15, 0xffff0000, v247
    v_lshlrev_b32 v16, 16, v240
    v_and_b32 v17, 0xffff0000, v240
    v_lshlrev_b32 v18, 16, v241
    v_and_b32 v19, 0xffff0000, v241
    v_lshlrev_b32 v20, 16, v242
    v_and_b32 v21, 0xffff0000, v242
    v_lshlrev_b32 v22, 16, v243
    v_and_b32 v23, 0xffff0000, v243
    v_pk_add_f32 v[40:41], v[40:41], v[8:9]
    v_pk_add_f32 v[42:43], v[42:43], v[10:11]
    v_pk_add_f32 v[224:225], v[224:225], v[12:13]
    v_pk_add_f32 v[226:227], v[226:227], v[14:15]
    s_waitcnt lgkmcnt(0)
    s_barrier
    ds_read_b128 v[64:67], v49
    ds_read_b128 v[68:71], v49 offset:1024
    ds_read_b128 v[72:75], v50 offset:2048
    ds_read_b128 v[76:79], v50 offset:3072
    ds_read_b128 v[80:83], v51 offset:4096
    ds_read_b128 v[84:87], v51 offset:5120
    s_waitcnt lgkmcnt(4)
    v_pk_add_f32 v[40:41], v[40:41], v[64:65]
    v_pk_add_f32 v[42:43], v[42:43], v[66:67]
    v_pk_add_f32 v[224:225], v[224:225], v[68:69]
    v_pk_add_f32 v[226:227], v[226:227], v[70:71]
    s_waitcnt lgkmcnt(0)
    v_pk_add_f32 v[72:73], v[72:73], v[80:81]
    v_pk_add_f32 v[74:75], v[74:75], v[82:83]
    v_pk_add_f32 v[76:77], v[76:77], v[84:85]
    v_pk_add_f32 v[78:79], v[78:79], v[86:87]
    v_pk_add_f32 v[40:41], v[40:41], v[72:73]
    v_pk_add_f32 v[42:43], v[42:43], v[74:75]
    v_pk_add_f32 v[224:225], v[224:225], v[76:77]
    v_pk_add_f32 v[226:227], v[226:227], v[78:79]
    s_waitcnt vmcnt(0)
    v_pk_fma_f32 v[40:41], v[40:41], v[128:129], v[16:17]
    v_pk_fma_f32 v[42:43], v[42:43], v[130:131], v[18:19]
    v_pk_fma_f32 v[224:225], v[224:225], v[132:133], v[20:21]
    v_pk_fma_f32 v[226:227], v[226:227], v[134:135], v[22:23]
    v_cvt_pk_bf16_f32 v8, v40, v41
    v_cvt_pk_bf16_f32 v9, v42, v43
    v_cvt_pk_bf16_f32 v10, v224, v225
    v_cvt_pk_bf16_f32 v11, v226, v227
    v_and_b32 v2, 15, v1
    v_mul_u32_u24 v2, 144, v2
    v_lshl_add_u32 v2, v3, 3, v2
    s_mul_i32 s3, s26, 2304
    s_lshl_b32 s7, s25, 6
    s_add_u32 s3, s3, s7
    s_add_u32 s3, s3, 65536
    v_add_u32 v2, s3, v2
    ds_write_b64 v2, v[8:9]
    ds_write_b64 v2, v[10:11] offset:32
    v_lshrrev_b32 v12, 3, v0
    v_and_b32 v13, 7, v0
    v_mul_u32_u24 v14, 144, v12
    v_lshl_add_u32 v14, v13, 4, v14
    v_add_u32 v14, 65536, v14
    v_lshlrev_b32 v12, 10, v12
    v_lshl_add_u32 v12, v13, 4, v12
    s_lshl_b32 s3, s54, 16
    s_lshl_b32 s7, s55, 7
    s_add_u32 s3, s3, s7
    s_waitcnt lgkmcnt(0)
    s_barrier
    ds_read_b128 v[16:19], v14
    s_waitcnt lgkmcnt(0)
    buffer_store_dwordx4 v[16:19], v12, s[12:15], s3 offen sc1
    s_cmp_lg_u32 s6, 0
    s_cbranch_scc1 adaLN_cond__ssm_conv_h3__mixer_s_mlp__prompt_kernel_ow104
    s_cmp_eq_u32 s44, 0
    s_cbranch_scc1 adaLN_cond__ssm_conv_h3__mixer_s_mlp__prompt_kernel_gf105
    s_lshl_b32 s3, s4, 5
    s_add_u32 s3, s3, s5
    s_lshl_b32 s3, s3, 7
    s_add_u32 s3, s3, 4423680
    v_lshlrev_b32 v253, 3, v1
    s_mov_b64 s[46:47], exec
    s_mov_b64 exec, 0xffff
    buffer_store_dwordx2 v[248:249], v253, s[28:31], s3 offen sc1
    s_mov_b64 exec, s[46:47]
    s_mov_b32 s44, 0
adaLN_cond__ssm_conv_h3__mixer_s_mlp__prompt_kernel_gf105:
adaLN_cond__ssm_conv_h3__mixer_s_mlp__prompt_kernel_ow104:
adaLN_cond__ssm_conv_h3__mixer_s_mlp__prompt_kernel_end:
    s_endpgm
code_end:
.section .rodata,"a"
.p2align 6
.amdhsa_kernel adaLN_cond__ssm_conv_h3__mixer_s_mlp__prompt_kernel
  .amdhsa_next_free_vgpr 254
  .amdhsa_next_free_sgpr 100
  .amdhsa_accum_offset 256
  .amdhsa_group_segment_fixed_size 0
  .amdhsa_kernarg_size 128
  .amdhsa_user_sgpr_count 2
  .amdhsa_user_sgpr_kernarg_segment_ptr 1
  .amdhsa_system_sgpr_workgroup_id_x 1
.end_amdhsa_kernel
```
